```python
import torch

def _softmax(x, axis=-1):
    return torch.softmax(x, dim=axis)
def _gelu(x):
    return torch.nn.functional.gelu(x, approximate="tanh")
def _silu(x):
    return torch.nn.functional.silu(x)
def _sigmoid(x):
    return torch.sigmoid(x)
def _layernorm(x, axis=-1, eps=1e-5):
    m = x.mean(dim=axis, keepdim=True)
    v = x.var(dim=axis, keepdim=True, unbiased=False)
    return (x - m) / torch.sqrt(v + eps)
def _scatter_add(tgt, idx, src, axis=0):
    return tgt.clone().index_add_(axis, idx, src)
def _segment_sum(src, seg, n):
    out = torch.zeros((n,) + src.shape[1:], dtype=src.dtype)
    return out.index_add_(0, seg, src)
def _pad(x, pw):
    flat = tuple(v for pair in reversed(pw) for v in pair)
    return torch.nn.functional.pad(x, flat)

kernel_name = 'recurrent_scan__compressed_kv_cla__glu_gated_swiglu__decode'

def setup_inputs():

    _w = (lambda a: (lambda t: t.to(torch.bfloat16) if t.is_floating_point() else t)(torch.as_tensor(a)))
    def _A_setup():
        B, H, Sq, Sk, D, M = 2, 32, 1, 8192, 128, 512
        Dc = 4 * D
        return {
            "x": _w((lambda *s: torch.randn(*s, dtype=torch.bfloat16) * 0.05)(B, Sq, M)),
            "c_kv": _w((lambda *s: torch.randn(*s, dtype=torch.bfloat16) * 1.6)(B, Sk, Dc)),
            "w_q": _w((lambda *s: torch.randn(*s, dtype=torch.bfloat16) * 1.6)(M, H, D) * (M ** -0.5)),
            "w_uk": _w((lambda *s: torch.randn(*s, dtype=torch.bfloat16) * 1.6)(Dc, H, D) * (Dc ** -0.5)),
            "w_uv": _w((lambda *s: torch.randn(*s, dtype=torch.bfloat16) * 1.6)(Dc, H, D) * (Dc ** -0.5)),
            "w_o": _w((lambda *s: torch.randn(*s, dtype=torch.bfloat16) * 1.6)(H, D, M) * ((H * D) ** -0.5)),
        }
    _A_in = _A_setup()

    def _B_setup():
        B, S, D, F = 2, 1, 512, 1376
        return {
            "x": _w((lambda *s: torch.randn(*s, dtype=torch.bfloat16) * 0.05)(B, S, D)),
            "w1": _w((lambda *s: torch.randn(*s, dtype=torch.bfloat16) * 0.2)(D, F) * (2.0 / D) ** 0.5),
            "w3": _w((lambda *s: torch.randn(*s, dtype=torch.bfloat16) * 0.2)(D, F) * (2.0 / D) ** 0.5),
            "w2": _w((lambda *s: torch.randn(*s, dtype=torch.bfloat16) * 0.2)(F, D) * (2.0 / F) ** 0.5),
        }
    _B_in = _B_setup()

    return {
        "A_x": _A_in["x"],
        "A_c_kv": _A_in["c_kv"],
        "A_w_q": _A_in["w_q"],
        "A_w_uk": _A_in["w_uk"],
        "A_w_uv": _A_in["w_uv"],
        "A_w_o": _A_in["w_o"],
        "B_x": _B_in["x"],
        "B_w1": _B_in["w1"],
        "B_w3": _B_in["w3"],
        "B_w2": _B_in["w2"],
    }

def reference(A_x, A_c_kv, A_w_q, A_w_uk, A_w_uv, A_w_o, B_x, B_w1, B_w3, B_w2):
    def _A_ref(x, c_kv, w_q, w_uk, w_uv, w_o):
        B, Sq, M = x.shape[0], x.shape[1], x.shape[2]
        Sk = c_kv.shape[1]
        H, D = w_q.shape[1], w_q.shape[2]
        q = torch.einsum("bqm,mhd->bhqd", x, w_q)
        k = torch.einsum("bkc,chd->bhkd", c_kv, w_uk)
        v = torch.einsum("bkc,chd->bhkd", c_kv, w_uv)
        scores = torch.einsum("bhqd,bhkd->bhqk", q, k) * (D ** -0.5)
        off = Sk - Sq
        qi = torch.arange(Sq)[:, None]
        kj = torch.arange(Sk)[None, :]
        cmask = kj <= (qi + off)
        scores = torch.where(cmask[None, None], scores, -1e9)
        p = _softmax(scores, axis=-1)
        ctx = torch.einsum("bhqk,bhkd->bhqd", p, v)
        return torch.einsum("bhqd,hdm->bqm", ctx, w_o)

    def _B_ref(x, w1, w3, w2):
        gate = torch.einsum("bsd,df->bsf", x, w1)
        up = torch.einsum("bsd,df->bsf", x, w3)
        h = _silu(gate) * up
        out = torch.einsum("bsf,fd->bsd", h, w2)
        return out

    x = A_x
    xn = _layernorm(x, axis=-1)
    s = _A_ref(xn, A_c_kv, A_w_q, A_w_uk, A_w_uv, A_w_o)
    g = _silu(_B_ref(xn, B_w1, B_w3, B_w2))
    return x + s * g
```

```asm
; @launch grid=(256,1,1) block=(512,1,1) lds=163840
.amdgcn_target "amdgcn-amd-amdhsa--gfx950"
.text
.globl recurrent_scan__compressed_kv_cla__glu_gated_swiglu__decode_kernel
.p2align 8
.type recurrent_scan__compressed_kv_cla__glu_gated_swiglu__decode_kernel,@function
recurrent_scan__compressed_kv_cla__glu_gated_swiglu__decode_kernel:
    s_cmp_ge_u32 s2, 256
    s_cbranch_scc1 L_end
    s_load_dwordx2 s[8:9], s[0:1], 0
    s_load_dwordx2 s[16:17], s[0:1], 16
    s_load_dwordx2 s[20:21], s[0:1], 24
    s_load_dwordx2 s[12:13], s[0:1], 8
    s_load_dwordx2 s[44:45], s[0:1], 96
    v_lshrrev_b32 v10, 6, v0
    v_and_b32 v1, 63, v0
    v_and_b32 v2, 15, v0
    v_readfirstlane_b32 s71, v10
    v_lshrrev_b32 v3, 4, v1
    v_lshlrev_b32 v4, 4, v1
    v_lshlrev_b32 v11, 4, v2
    v_lshl_add_u32 v5, v3, 13, v11
    s_mov_b32 s11, 0x20000
    s_movk_i32 s10, 2048
    s_mov_b32 s14, 16777216
    s_mov_b32 s15, s11
    s_mov_b32 s18, 4194304
    s_mov_b32 s19, s11
    s_mov_b32 s22, s18
    s_mov_b32 s23, s11
    s_brev_b32 s46, 8
    s_mov_b32 s47, s11
    s_and_b32 s3, s71, 3
    s_and_b32 s52, s2, 7
    s_lshr_b32 s68, s2, 6
    s_lshl_b32 s59, s52, 2
    s_add_u32 s54, s68, s59
    s_bfe_u32 s55, s2, 0x20004
    s_lshl_b32 s65, s55, 1
    s_and_b32 s59, s3, 1
    s_add_u32 s65, s65, s59
    s_lshl_b32 s5, s65, 19
    s_lshl_b32 s58, s54, 8
    s_add_u32 s5, s5, s58
    s_movk_i32 s6, 0x2000
    s_bfe_u32 s57, s2, 0x10003
    s_lshr_b32 s58, s71, 2
    s_lshl_b32 s58, s58, 1
    s_or_b32 s58, s58, s57
    s_cmp_eq_u32 s58, 3
    s_cbranch_scc1 L_A0
    s_cmp_eq_u32 s58, 1
    s_cbranch_scc1 L_S0
    s_cmp_eq_u32 s58, 2
    s_cbranch_scc1 L_PF
    s_lshl_b32 s66, s59, 15
    s_lshr_b32 s59, s3, 1
    s_lshl_b32 s58, s59, 13
    s_add_u32 m0, s66, s58
    s_lshl_b32 s58, s59, 18
    s_add_u32 s5, s5, s58
    s_lshl_b32 s7, s6, 2
    v_lshrrev_b32 v10, 1, v3
    v_lshlrev_b32 v10, 4, v10
    v_xor_b32 v10, v5, v10
    s_mov_b32 s59, 0
    s_waitcnt lgkmcnt(0)
    s_load_dword s4, s[44:45], 0
L_F0:
    v_xor_b32 v11, s59, v10
    s_add_u32 s59, s59, 32
    buffer_load_dwordx4 v11, s[20:23], s5 offen nt lds
    s_add_u32 s5, s5, s7
    s_addk_i32 m0, 0x400
    s_cmpk_lt_u32 s59, 0x100
    s_cbranch_scc1 L_F0
    s_barrier
    s_branch L_F
L_S0:
    s_lshr_b32 s58, s2, 4
    s_lshl_b32 s56, s52, 4
    s_add_u32 s56, s56, s58
    s_lshl_b32 s66, s3, 15
    s_lshl_b32 s67, s56, 17
    s_add_u32 s67, s67, s66
    s_mov_b32 m0, s66
    s_waitcnt lgkmcnt(0)
    s_load_dword s4, s[44:45], 0
    s_barrier
    buffer_load_dwordx4 v4, s[12:15], s67 offen lds
    v_xor_b32 v11, 32, v4
    buffer_load_dwordx4 v11, s[12:15], s67 offen offset:1024 lds
    v_xor_b32 v11, 64, v4
    buffer_load_dwordx4 v11, s[12:15], s67 offen offset:2048 lds
    s_branch L_S
L_PF:
    s_getpc_b64 s[62:63]
L_pc:
    s_lshr_b32 s58, s2, 4
    s_lshl_b32 s58, s58, 2
    s_add_u32 s58, s58, s3
    s_mul_i32 s58, s58, 512
    v_lshl_add_u32 v10, v1, 7, s58
    v_min_u32 v10, L_end-L_pc, v10
    s_mov_b64 exec, 15
    global_load_dword v60, v10, s[62:63]
    s_mov_b64 exec, -1
    s_lshl_b32 s58, s54, 2
    s_add_u32 s58, s58, s3
    s_lshl_b32 s59, s58, 11
    s_add_u32 s59, s59, 1376256
    s_lshl_b32 s58, s58, 10
    s_add_u32 s58, s58, 1638400
    s_waitcnt lgkmcnt(0)
    buffer_load_dwordx4 v[60:63], v4, s[44:47], s59 offen sc1
    buffer_load_dwordx4 v[60:63], v4, s[44:47], s59 offen offset:1024 sc1
    buffer_load_dwordx4 v[60:63], v4, s[44:47], s58 offen sc1
    s_barrier
    s_barrier
    s_branch L_T
L_A0:
    s_cmp_ge_u32 s3, 2
    s_cbranch_scc1 L_H23
    s_lshl_b32 s59, s65, 7
    v_lshl_add_u32 v13, v3, 17, v11
    v_bfe_u32 v10, v1, 3, 1
    v_lshlrev_b32 v10, 10, v10
    v_and_b32 v12, 7, v1
    v_lshl_add_u32 v12, v12, 5, v10
    v_lshl_add_u32 v12, v3, 8, v12
    v_lshl_add_u32 v10, v3, 5, v10
    s_waitcnt lgkmcnt(0)
    s_load_dword s4, s[44:45], 0
    buffer_load_dwordx4 v[16:19], v12, s[8:11], 0 offen
    buffer_load_dwordx4 v[20:23], v12, s[8:11], 0 offen offset:16
    buffer_load_dwordx4 v[24:27], v10, s[8:11], s59 offen
    buffer_load_dwordx4 v[28:31], v10, s[8:11], s59 offen offset:16
    buffer_load_dwordx4 v[64:67], v13, s[16:19], s5 offen nt
    s_add_u32 s5, s5, s6
    buffer_load_dwordx4 v[68:71], v13, s[16:19], s5 offen nt
    s_add_u32 s5, s5, s6
    buffer_load_dwordx4 v[72:75], v13, s[16:19], s5 offen nt
    s_add_u32 s5, s5, s6
    buffer_load_dwordx4 v[76:79], v13, s[16:19], s5 offen nt
    s_add_u32 s5, s5, s6
    buffer_load_dwordx4 v[80:83], v13, s[16:19], s5 offen nt
    s_add_u32 s5, s5, s6
    buffer_load_dwordx4 v[84:87], v13, s[16:19], s5 offen nt
    s_add_u32 s5, s5, s6
    buffer_load_dwordx4 v[88:91], v13, s[16:19], s5 offen nt
    s_add_u32 s5, s5, s6
    buffer_load_dwordx4 v[92:95], v13, s[16:19], s5 offen nt
    s_add_u32 s5, s5, s6
    buffer_load_dwordx4 v[96:99], v13, s[16:19], s5 offen nt
    s_add_u32 s5, s5, s6
    buffer_load_dwordx4 v[100:103], v13, s[16:19], s5 offen nt
    s_add_u32 s5, s5, s6
    buffer_load_dwordx4 v[104:107], v13, s[16:19], s5 offen nt
    s_add_u32 s5, s5, s6
    buffer_load_dwordx4 v[108:111], v13, s[16:19], s5 offen nt
    s_add_u32 s5, s5, s6
    buffer_load_dwordx4 v[112:115], v13, s[16:19], s5 offen nt
    s_add_u32 s5, s5, s6
    buffer_load_dwordx4 v[116:119], v13, s[16:19], s5 offen nt
    s_add_u32 s5, s5, s6
    buffer_load_dwordx4 v[120:123], v13, s[16:19], s5 offen nt
    s_add_u32 s5, s5, s6
    buffer_load_dwordx4 v[124:127], v13, s[16:19], s5 offen nt
    s_add_u32 s5, s5, s6
    s_barrier
    s_lshl_b32 s68, s68, 3
    s_add_u32 s68, s68, s52
    s_lshr_b32 s58, s2, 4
    s_lshl_b32 s56, s52, 4
    s_add_u32 s56, s56, s58
    s_mul_i32 s58, s52, 3
    s_max_u32 s59, s52, 6
    s_sub_u32 s58, s58, s59
    s_add_u32 s58, s58, 6
    s_lshr_b32 s59, s68, 3
    s_add_u32 s58, s58, s59
    s_lshl_b32 s59, s58, 1
    s_cmp_ge_u32 s58, 11
    s_cselect_b32 s58, 21, 0
    s_sub_u32 s59, s59, s58
    s_cmp_lt_u32 s68, 22
    s_cselect_b32 s68, s59, s68
    s_lshl_b32 s66, s3, 15
    s_lshl_b32 s67, s56, 17
    s_add_u32 s67, s67, s66
    s_mov_b32 s85, 0
    s_lshl_b32 s5, s54, 3
    s_add_u32 s5, s5, s65
    s_lshl_b32 s5, s5, 10
    s_add_u32 s5, s5, 65536
    s_add_u32 s69, s5, 1310720
    v_mov_b32 v56, -1
    v_mov_b32 v57, -1
    v_mov_b32 v58, -1
    v_mov_b32 v59, -1
    s_lshl_b32 s6, s68, 3
    s_add_u32 s6, s6, s65
    s_lshl_b32 s6, s6, 10
    s_add_u32 s6, s6, 720896
    s_cmp_lt_u32 s68, 22
    s_cselect_b32 s6, s6, s5
    buffer_store_dwordx4 v[56:59], v4, s[44:47], s6 offen sc1
    v_and_b32 v10, 1, v1
    v_cmp_eq_u32 vcc, 1, v10
    v_mov_b32 v11, 0xffff
    v_mov_b32 v12, 0xffff0000
    v_cndmask_b32 v11, v11, v12, vcc
    v_bfe_u32 v10, v1, 1, 2
    v_cmp_eq_u32 vcc, 0, v10
    s_nop 1
    v_cndmask_b32 v6, 0, v11, vcc
    v_cmp_eq_u32 vcc, 1, v10
    s_nop 1
    v_cndmask_b32 v7, 0, v11, vcc
    v_cmp_eq_u32 vcc, 2, v10
    s_nop 1
    v_cndmask_b32 v8, 0, v11, vcc
    v_cmp_eq_u32 vcc, 3, v10
    s_nop 1
    v_cndmask_b32 v9, 0, v11, vcc
    s_waitcnt lgkmcnt(0)
    s_add_u32 s7, s4, 1
    s_lshl_b32 s4, s7, 2
    s_and_b32 s4, s4, 0x3fff0000
    s_and_b32 s58, s7, 0x3fff
    s_or_b32 s4, s4, s58
    v_and_b32 v10, 16, v1
    v_cmp_ne_u32 vcc, 0, v10
    v_mov_b32 v10, s4
    v_mov_b32 v11, 0
    v_mov_b32 v52, 0x3f803f80
    v_mov_b32 v48, 0
    v_mov_b32 v49, 0
    v_mov_b32 v50, 0
    v_mov_b32 v51, 0
    s_waitcnt vmcnt(19)
    v_dot2c_f32_bf16 v48, v16, v52
    v_dot2c_f32_bf16 v50, v16, v16
    v_dot2c_f32_bf16 v49, v17, v52
    v_dot2c_f32_bf16 v51, v17, v17
    v_dot2c_f32_bf16 v48, v18, v52
    v_dot2c_f32_bf16 v50, v18, v18
    v_dot2c_f32_bf16 v49, v19, v52
    v_dot2c_f32_bf16 v51, v19, v19
    v_dot2c_f32_bf16 v48, v20, v52
    v_dot2c_f32_bf16 v50, v20, v20
    v_dot2c_f32_bf16 v49, v21, v52
    v_dot2c_f32_bf16 v51, v21, v21
    v_dot2c_f32_bf16 v48, v22, v52
    v_dot2c_f32_bf16 v50, v22, v22
    v_dot2c_f32_bf16 v49, v23, v52
    v_dot2c_f32_bf16 v51, v23, v23
    s_waitcnt vmcnt(17)
    s_nop 1
    v_add_f32 v48, v48, v49
    v_add_f32 v50, v50, v51
    s_nop 0
    v_add_f32_dpp v48, v48, v48 quad_perm:[1,0,3,2] row_mask:0xf bank_mask:0xf
    v_add_f32_dpp v50, v50, v50 quad_perm:[1,0,3,2] row_mask:0xf bank_mask:0xf
    v_lshlrev_b32 v32, 16, v24
    v_add_f32_dpp v48, v48, v48 quad_perm:[2,3,0,1] row_mask:0xf bank_mask:0xf
    v_add_f32_dpp v50, v50, v50 quad_perm:[2,3,0,1] row_mask:0xf bank_mask:0xf
    v_and_b32 v33, 0xffff0000, v24
    v_add_f32_dpp v48, v48, v48 row_half_mirror row_mask:0xf bank_mask:0xf
    v_add_f32_dpp v50, v50, v50 row_half_mirror row_mask:0xf bank_mask:0xf
    v_lshlrev_b32 v34, 16, v25
    v_mov_b32 v49, v48
    v_mov_b32 v51, v50
    v_and_b32 v35, 0xffff0000, v25
    v_permlane16_swap_b32 v49, v48
    v_permlane16_swap_b32 v51, v50
    v_lshlrev_b32 v36, 16, v26
    v_add_f32 v48, v49, v48
    v_add_f32 v50, v51, v50
    v_and_b32 v37, 0xffff0000, v26
    v_mov_b32 v49, v48
    v_mov_b32 v51, v50
    v_lshlrev_b32 v38, 16, v27
    v_permlane32_swap_b32 v49, v48
    v_permlane32_swap_b32 v51, v50
    v_and_b32 v39, 0xffff0000, v27
    v_add_f32 v48, v49, v48
    v_add_f32 v50, v51, v50
    v_lshlrev_b32 v40, 16, v28
    v_mul_f32 v48, 0x3b000000, v48
    v_mul_f32 v50, 0x3b000000, v50
    v_fma_f32 v50, -v48, v48, v50
    v_max_f32 v50, 0, v50
    v_cvt_pk_bf16_f32 v48, v48, v48
    v_cvt_pk_bf16_f32 v50, v50, v50
    v_and_b32 v48, 0xffff0000, v48
    v_and_b32 v50, 0xffff0000, v50
    v_add_f32 v50, 0x3727c5ac, v50
    v_cvt_pk_bf16_f32 v50, v50, v50
    v_and_b32 v50, 0xffff0000, v50
    v_sqrt_f32 v50, v50
    v_and_b32 v41, 0xffff0000, v28
    v_cvt_pk_bf16_f32 v50, v50, v50
    v_and_b32 v50, 0xffff0000, v50
    v_rcp_f32 v50, v50
    v_lshlrev_b32 v42, 16, v29
    v_and_b32 v43, 0xffff0000, v29
    v_lshlrev_b32 v44, 16, v30
    v_and_b32 v45, 0xffff0000, v30
    v_lshlrev_b32 v46, 16, v31
    v_and_b32 v47, 0xffff0000, v31
    v_mul_f32 v48, v48, v50
    v_fma_f32 v32, v32, v50, -v48
    v_fma_f32 v33, v33, v50, -v48
    v_cvt_pk_bf16_f32 v32, v32, v32
    v_fma_f32 v34, v34, v50, -v48
    v_cvt_pk_bf16_f32 v33, v33, v33
    v_fma_f32 v35, v35, v50, -v48
    v_cvt_pk_bf16_f32 v34, v34, v34
    v_fma_f32 v36, v36, v50, -v48
    v_cvt_pk_bf16_f32 v35, v35, v35
    v_fma_f32 v37, v37, v50, -v48
    v_cvt_pk_bf16_f32 v36, v36, v36
    v_fma_f32 v38, v38, v50, -v48
    v_cvt_pk_bf16_f32 v37, v37, v37
    v_fma_f32 v39, v39, v50, -v48
    v_cvt_pk_bf16_f32 v38, v38, v38
    v_fma_f32 v40, v40, v50, -v48
    v_cvt_pk_bf16_f32 v39, v39, v39
    v_fma_f32 v41, v41, v50, -v48
    v_cvt_pk_bf16_f32 v40, v40, v40
    v_fma_f32 v42, v42, v50, -v48
    v_cvt_pk_bf16_f32 v41, v41, v41
    v_fma_f32 v43, v43, v50, -v48
    v_cvt_pk_bf16_f32 v42, v42, v42
    v_fma_f32 v44, v44, v50, -v48
    v_cvt_pk_bf16_f32 v43, v43, v43
    v_fma_f32 v45, v45, v50, -v48
    v_cvt_pk_bf16_f32 v44, v44, v44
    v_fma_f32 v46, v46, v50, -v48
    v_cvt_pk_bf16_f32 v45, v45, v45
    v_fma_f32 v47, v47, v50, -v48
    v_cvt_pk_bf16_f32 v46, v46, v46
    v_cvt_pk_bf16_f32 v47, v47, v47
    v_and_b32 v192, v32, v6
    v_and_b32 v193, v32, v7
    v_and_b32 v194, v32, v8
    v_and_b32 v195, v32, v9
    v_and_b32 v196, v33, v6
    v_and_b32 v197, v33, v7
    v_and_b32 v198, v33, v8
    v_and_b32 v199, v33, v9
    s_waitcnt vmcnt(15)
    v_mfma_f32_16x16x32_bf16 v[12:15], v[192:195], v[64:67], 0
    v_and_b32 v200, v34, v6
    v_and_b32 v201, v34, v7
    v_and_b32 v202, v34, v8
    v_and_b32 v203, v34, v9
    v_mfma_f32_16x16x32_bf16 v[12:15], v[196:199], v[68:71], v[12:15]
    v_and_b32 v204, v35, v6
    v_and_b32 v205, v35, v7
    v_and_b32 v206, v35, v8
    v_and_b32 v207, v35, v9
    s_waitcnt vmcnt(13)
    v_mfma_f32_16x16x32_bf16 v[12:15], v[200:203], v[72:75], v[12:15]
    v_and_b32 v208, v36, v6
    v_and_b32 v209, v36, v7
    v_and_b32 v210, v36, v8
    v_and_b32 v211, v36, v9
    v_mfma_f32_16x16x32_bf16 v[12:15], v[204:207], v[76:79], v[12:15]
    v_and_b32 v212, v37, v6
    v_and_b32 v213, v37, v7
    v_and_b32 v214, v37, v8
    v_and_b32 v215, v37, v9
    s_waitcnt vmcnt(11)
    v_mfma_f32_16x16x32_bf16 v[12:15], v[208:211], v[80:83], v[12:15]
    v_and_b32 v216, v38, v6
    v_and_b32 v217, v38, v7
    v_and_b32 v218, v38, v8
    v_and_b32 v219, v38, v9
    v_mfma_f32_16x16x32_bf16 v[12:15], v[212:215], v[84:87], v[12:15]
    v_and_b32 v220, v39, v6
    v_and_b32 v221, v39, v7
    v_and_b32 v222, v39, v8
    v_and_b32 v223, v39, v9
    s_waitcnt vmcnt(9)
    v_mfma_f32_16x16x32_bf16 v[12:15], v[216:219], v[88:91], v[12:15]
    v_and_b32 v224, v40, v6
    v_and_b32 v225, v40, v7
    v_and_b32 v226, v40, v8
    v_and_b32 v227, v40, v9
    v_mfma_f32_16x16x32_bf16 v[12:15], v[220:223], v[92:95], v[12:15]
    v_and_b32 v228, v41, v6
    v_and_b32 v229, v41, v7
    v_and_b32 v230, v41, v8
    v_and_b32 v231, v41, v9
    s_waitcnt vmcnt(7)
    v_mfma_f32_16x16x32_bf16 v[12:15], v[224:227], v[96:99], v[12:15]
    v_and_b32 v232, v42, v6
    v_and_b32 v233, v42, v7
    v_and_b32 v234, v42, v8
    v_and_b32 v235, v42, v9
    v_mfma_f32_16x16x32_bf16 v[12:15], v[228:231], v[100:103], v[12:15]
    v_and_b32 v236, v43, v6
    v_and_b32 v237, v43, v7
    v_and_b32 v238, v43, v8
    v_and_b32 v239, v43, v9
    s_waitcnt vmcnt(5)
    v_mfma_f32_16x16x32_bf16 v[12:15], v[232:235], v[104:107], v[12:15]
    v_and_b32 v240, v44, v6
    v_and_b32 v241, v44, v7
    v_and_b32 v242, v44, v8
    v_and_b32 v243, v44, v9
    v_mfma_f32_16x16x32_bf16 v[12:15], v[236:239], v[108:111], v[12:15]
    v_and_b32 v244, v45, v6
    v_and_b32 v245, v45, v7
    v_and_b32 v246, v45, v8
    v_and_b32 v247, v45, v9
    s_waitcnt vmcnt(3)
    v_mfma_f32_16x16x32_bf16 v[12:15], v[240:243], v[112:115], v[12:15]
    v_and_b32 v248, v46, v6
    v_and_b32 v249, v46, v7
    v_and_b32 v250, v46, v8
    v_and_b32 v251, v46, v9
    v_mfma_f32_16x16x32_bf16 v[12:15], v[244:247], v[116:119], v[12:15]
    v_and_b32 v252, v47, v6
    v_and_b32 v253, v47, v7
    v_and_b32 v254, v47, v8
    v_and_b32 v255, v47, v9
    s_waitcnt vmcnt(1)
    v_mfma_f32_16x16x32_bf16 v[12:15], v[248:251], v[120:123], v[12:15]
    v_mfma_f32_16x16x32_bf16 v[12:15], v[252:255], v[124:127], v[12:15]
    s_nop 7
    v_cvt_pk_bf16_f32 v16, v12, v13
    v_cvt_pk_bf16_f32 v17, v14, v15
    v_cndmask_b32 v12, v11, v16, vcc
    v_cndmask_b32 v13, v10, v17, vcc
    v_cndmask_b32 v14, v16, v10, vcc
    v_cndmask_b32 v15, v17, v11, vcc
    buffer_store_dwordx4 v[12:15], v4, s[44:47], s69 offen
    s_barrier
    v_mov_b32 v52, v12
    v_mov_b32 v53, v13
    v_mov_b32 v54, v14
    v_mov_b32 v55, v15
    s_load_dwordx2 s[32:33], s[0:1], 56
    s_load_dwordx2 s[36:37], s[0:1], 64
    s_load_dwordx2 s[48:49], s[0:1], 80
    s_load_dwordx2 s[28:29], s[0:1], 40
    s_mov_b32 s34, 1409024
    s_mov_b32 s35, 0x20000
    s_mov_b32 s38, 1409024
    s_mov_b32 s39, 0x20000
    s_mov_b32 s50, 2048
    s_mov_b32 s51, 0x20000
    s_mov_b32 s30, 4194304
    s_mov_b32 s31, 0x20000
    s_lshl_b32 s87, s54, 17
    s_lshl_b32 s58, s3, 16
    s_add_u32 s87, s87, s58
    s_lshl_b32 s58, s55, 8
    s_add_u32 s87, s87, s58
    v_lshlrev_b32 v61, 4, v2
    v_lshl_add_u32 v61, v3, 10, v61
    s_waitcnt lgkmcnt(0)
    s_cmp_ge_u32 s68, 28
    s_cbranch_scc1 L_R
    s_cmp_lt_u32 s68, 22
    s_cbranch_scc1 L_U1
    s_barrier
    buffer_store_dwordx4 v[52:55], v4, s[44:47], s69 offen sc1
    s_barrier
    s_barrier
    s_barrier
    buffer_load_dwordx4 v[56:59], v61, s[28:31], s87 offen
    s_add_u32 s87, s87, 4096
    buffer_load_dwordx4 v[56:59], v61, s[28:31], s87 offen
    s_add_u32 s87, s87, 4096
    buffer_load_dwordx4 v[56:59], v61, s[28:31], s87 offen
    s_add_u32 s87, s87, 4096
    buffer_load_dwordx4 v[56:59], v61, s[28:31], s87 offen
    s_add_u32 s87, s87, 4096
    buffer_load_dwordx4 v[56:59], v61, s[28:31], s87 offen
    s_add_u32 s87, s87, 4096
    buffer_load_dwordx4 v[56:59], v61, s[28:31], s87 offen
    s_add_u32 s87, s87, 4096
    buffer_load_dwordx4 v[56:59], v61, s[28:31], s87 offen
    s_add_u32 s87, s87, 4096
    buffer_load_dwordx4 v[56:59], v61, s[28:31], s87 offen
    s_add_u32 s87, s87, 4096
    buffer_load_dwordx4 v[56:59], v61, s[28:31], s87 offen
    s_add_u32 s87, s87, 4096
    buffer_load_dwordx4 v[56:59], v61, s[28:31], s87 offen
    s_add_u32 s87, s87, 4096
    buffer_load_dwordx4 v[56:59], v61, s[28:31], s87 offen
    s_add_u32 s87, s87, 4096
    buffer_load_dwordx4 v[56:59], v61, s[28:31], s87 offen
    s_add_u32 s87, s87, 4096
    buffer_load_dwordx4 v[56:59], v61, s[28:31], s87 offen
    s_add_u32 s87, s87, 4096
    buffer_load_dwordx4 v[56:59], v61, s[28:31], s87 offen
    s_add_u32 s87, s87, 4096
    buffer_load_dwordx4 v[56:59], v61, s[28:31], s87 offen
    s_add_u32 s87, s87, 4096
    buffer_load_dwordx4 v[56:59], v61, s[28:31], s87 offen
    s_add_u32 s87, s87, 4096
    s_branch L_fin
L_U1:
    s_bitcmp1_b32 s68, 0
    s_cselect_b32 s16, s36, s32
    s_cselect_b32 s17, s37, s33
    s_mov_b32 s18, 1409024
    s_mov_b32 s19, 0x20000
    s_mul_i32 s5, s65, 176128
    s_lshr_b32 s58, s68, 1
    s_lshl_b32 s58, s58, 8
    s_add_u32 s5, s5, s58
    s_mov_b32 s58, 44032
    v_mul_lo_u32 v50, v3, s58
    v_lshl_add_u32 v50, v2, 4, v50
    s_lshl_b32 s6, s68, 3
    s_add_u32 s6, s6, s65
    s_lshl_b32 s6, s6, 10
    s_add_u32 s6, s6, 720896
    s_barrier
    buffer_store_dwordx4 v[52:55], v4, s[44:47], s69 offen sc1
    buffer_load_dwordx4 v[64:67], v50, s[16:19], s5 offen nt
    s_add_u32 s5, s5, 2752
    buffer_load_dwordx4 v[68:71], v50, s[16:19], s5 offen nt
    s_add_u32 s5, s5, 2752
    buffer_load_dwordx4 v[72:75], v50, s[16:19], s5 offen nt
    s_add_u32 s5, s5, 2752
    buffer_load_dwordx4 v[76:79], v50, s[16:19], s5 offen nt
    s_add_u32 s5, s5, 2752
    buffer_load_dwordx4 v[80:83], v50, s[16:19], s5 offen nt
    s_add_u32 s5, s5, 2752
    buffer_load_dwordx4 v[84:87], v50, s[16:19], s5 offen nt
    s_add_u32 s5, s5, 2752
    buffer_load_dwordx4 v[88:91], v50, s[16:19], s5 offen nt
    s_add_u32 s5, s5, 2752
    buffer_load_dwordx4 v[92:95], v50, s[16:19], s5 offen nt
    s_add_u32 s5, s5, 2752
    buffer_load_dwordx4 v[96:99], v50, s[16:19], s5 offen nt
    s_add_u32 s5, s5, 2752
    buffer_load_dwordx4 v[100:103], v50, s[16:19], s5 offen nt
    s_add_u32 s5, s5, 2752
    buffer_load_dwordx4 v[104:107], v50, s[16:19], s5 offen nt
    s_add_u32 s5, s5, 2752
    buffer_load_dwordx4 v[108:111], v50, s[16:19], s5 offen nt
    s_add_u32 s5, s5, 2752
    buffer_load_dwordx4 v[112:115], v50, s[16:19], s5 offen nt
    s_add_u32 s5, s5, 2752
    buffer_load_dwordx4 v[116:119], v50, s[16:19], s5 offen nt
    s_add_u32 s5, s5, 2752
    buffer_load_dwordx4 v[120:123], v50, s[16:19], s5 offen nt
    s_add_u32 s5, s5, 2752
    buffer_load_dwordx4 v[124:127], v50, s[16:19], s5 offen nt
    s_add_u32 s5, s5, 2752
    s_barrier
    s_barrier
    s_waitcnt vmcnt(12)
    v_mfma_f32_16x16x32_bf16 v[12:15], v[192:195], v[64:67], 0
    v_mfma_f32_16x16x32_bf16 v[12:15], v[196:199], v[68:71], v[12:15]
    v_mfma_f32_16x16x32_bf16 v[12:15], v[200:203], v[72:75], v[12:15]
    v_mfma_f32_16x16x32_bf16 v[12:15], v[204:207], v[76:79], v[12:15]
    s_waitcnt vmcnt(8)
    v_mfma_f32_16x16x32_bf16 v[12:15], v[208:211], v[80:83], v[12:15]
    v_mfma_f32_16x16x32_bf16 v[12:15], v[212:215], v[84:87], v[12:15]
    v_mfma_f32_16x16x32_bf16 v[12:15], v[216:219], v[88:91], v[12:15]
    v_mfma_f32_16x16x32_bf16 v[12:15], v[220:223], v[92:95], v[12:15]
    s_waitcnt vmcnt(4)
    v_mfma_f32_16x16x32_bf16 v[12:15], v[224:227], v[96:99], v[12:15]
    v_mfma_f32_16x16x32_bf16 v[12:15], v[228:231], v[100:103], v[12:15]
    v_mfma_f32_16x16x32_bf16 v[12:15], v[232:235], v[104:107], v[12:15]
    v_mfma_f32_16x16x32_bf16 v[12:15], v[236:239], v[108:111], v[12:15]
    s_waitcnt vmcnt(0)
    v_mfma_f32_16x16x32_bf16 v[12:15], v[240:243], v[112:115], v[12:15]
    v_mfma_f32_16x16x32_bf16 v[12:15], v[244:247], v[116:119], v[12:15]
    v_mfma_f32_16x16x32_bf16 v[12:15], v[248:251], v[120:123], v[12:15]
    v_mfma_f32_16x16x32_bf16 v[12:15], v[252:255], v[124:127], v[12:15]
    s_nop 7
    v_cvt_pk_bf16_f32 v12, v12, v13
    v_cvt_pk_bf16_f32 v13, v14, v15
    v_mov_b32 v14, s4
    v_mov_b32 v15, 0
    buffer_store_dwordx4 v[12:15], v4, s[44:47], s6 offen sc1
    s_barrier
    buffer_load_dwordx4 v[56:59], v61, s[28:31], s87 offen
    s_add_u32 s87, s87, 4096
    buffer_load_dwordx4 v[56:59], v61, s[28:31], s87 offen
    s_add_u32 s87, s87, 4096
    buffer_load_dwordx4 v[56:59], v61, s[28:31], s87 offen
    s_add_u32 s87, s87, 4096
    buffer_load_dwordx4 v[56:59], v61, s[28:31], s87 offen
    s_add_u32 s87, s87, 4096
    buffer_load_dwordx4 v[56:59], v61, s[28:31], s87 offen
    s_add_u32 s87, s87, 4096
    buffer_load_dwordx4 v[56:59], v61, s[28:31], s87 offen
    s_add_u32 s87, s87, 4096
    buffer_load_dwordx4 v[56:59], v61, s[28:31], s87 offen
    s_add_u32 s87, s87, 4096
    buffer_load_dwordx4 v[56:59], v61, s[28:31], s87 offen
    s_add_u32 s87, s87, 4096
    buffer_load_dwordx4 v[56:59], v61, s[28:31], s87 offen
    s_add_u32 s87, s87, 4096
    buffer_load_dwordx4 v[56:59], v61, s[28:31], s87 offen
    s_add_u32 s87, s87, 4096
    buffer_load_dwordx4 v[56:59], v61, s[28:31], s87 offen
    s_add_u32 s87, s87, 4096
    buffer_load_dwordx4 v[56:59], v61, s[28:31], s87 offen
    s_add_u32 s87, s87, 4096
    buffer_load_dwordx4 v[56:59], v61, s[28:31], s87 offen
    s_add_u32 s87, s87, 4096
    buffer_load_dwordx4 v[56:59], v61, s[28:31], s87 offen
    s_add_u32 s87, s87, 4096
    buffer_load_dwordx4 v[56:59], v61, s[28:31], s87 offen
    s_add_u32 s87, s87, 4096
    buffer_load_dwordx4 v[56:59], v61, s[28:31], s87 offen
    s_add_u32 s87, s87, 4096
    s_branch L_fin
    s_waitcnt vmcnt(0)
    s_barrier
    s_branch L_fin
L_H23:
    s_lshl_b32 s58, s68, 3
    s_add_u32 s58, s58, s52
    s_cmp_ge_u32 s58, 22
    s_cbranch_scc1 L_end
    s_waitcnt lgkmcnt(0)
    s_barrier
    s_load_dword s4, s[44:45], 0
    s_lshl_b32 s68, s68, 3
    s_add_u32 s68, s68, s52
    s_lshr_b32 s58, s2, 4
    s_lshl_b32 s56, s52, 4
    s_add_u32 s56, s56, s58
    s_mul_i32 s58, s52, 3
    s_max_u32 s59, s52, 6
    s_sub_u32 s58, s58, s59
    s_add_u32 s58, s58, 6
    s_lshr_b32 s59, s68, 3
    s_add_u32 s58, s58, s59
    s_lshl_b32 s59, s58, 1
    s_cmp_ge_u32 s58, 11
    s_cselect_b32 s58, 21, 0
    s_sub_u32 s59, s59, s58
    s_cmp_lt_u32 s68, 22
    s_cselect_b32 s68, s59, s68
    s_lshl_b32 s66, s3, 15
    s_lshl_b32 s67, s56, 17
    s_add_u32 s67, s67, s66
    s_mov_b32 s85, 0
    s_load_dwordx2 s[40:41], s[0:1], 72
    s_load_dwordx2 s[28:29], s[0:1], 40
    s_mov_b32 s42, 1409024
    s_mov_b32 s43, 0x20000
    s_mov_b32 s30, 4194304
    s_mov_b32 s31, 0x20000
    s_lshl_b32 s87, s54, 17
    s_and_b32 s58, s3, 1
    s_lshl_b32 s58, s58, 16
    s_add_u32 s87, s87, s58
    s_lshl_b32 s58, s55, 8
    s_add_u32 s87, s87, s58
    v_lshlrev_b32 v61, 4, v2
    v_lshl_add_u32 v61, v3, 10, v61
    s_barrier
    v_and_b32 v10, 1, v1
    v_cmp_eq_u32 vcc, 1, v10
    v_mov_b32 v11, 0xffff
    v_mov_b32 v12, 0xffff0000
    v_cndmask_b32 v11, v11, v12, vcc
    v_bfe_u32 v10, v1, 1, 2
    v_cmp_eq_u32 vcc, 0, v10
    s_nop 1
    v_cndmask_b32 v6, 0, v11, vcc
    v_cmp_eq_u32 vcc, 1, v10
    s_nop 1
    v_cndmask_b32 v7, 0, v11, vcc
    v_cmp_eq_u32 vcc, 2, v10
    s_nop 1
    v_cndmask_b32 v8, 0, v11, vcc
    v_cmp_eq_u32 vcc, 3, v10
    s_nop 1
    v_cndmask_b32 v9, 0, v11, vcc
    s_waitcnt lgkmcnt(0)
    s_add_u32 s7, s4, 1
    s_lshl_b32 s4, s7, 2
    s_and_b32 s4, s4, 0x3fff0000
    s_and_b32 s58, s7, 0x3fff
    s_or_b32 s4, s4, s58
    s_lshr_b32 s54, s68, 1
    s_and_b32 s69, s68, 1
    s_lshl_b32 s6, s69, 1
    s_add_u32 s6, s6, s3
    s_sub_u32 s6, s6, 2
    s_lshl_b32 s62, s54, 17
    s_lshl_b32 s58, s6, 15
    s_add_u32 s62, s62, s58
    s_lshl_b32 s58, s55, 8
    s_add_u32 s62, s62, s58
    s_and_b32 s59, s3, 1
    s_lshl_b32 s5, s54, 14
    s_lshl_b32 s58, s69, 7
    s_add_u32 s5, s5, s58
    s_lshl_b32 s58, s59, 6
    s_add_u32 s5, s5, s58
    s_add_u32 s5, s5, 720896
    s_lshl_b32 s70, s59, 12
    s_add_u32 s70, s70, 131072
    v_lshlrev_b32 v10, 10, v3
    v_bfe_u32 v11, v1, 2, 2
    v_lshl_add_u32 v10, v11, 8, v10
    v_and_b32 v12, 3, v1
    v_lshl_add_u32 v16, v12, 4, v10
    v_lshlrev_b32 v10, 8, v12
    v_lshl_add_u32 v10, v11, 6, v10
    v_lshl_add_u32 v10, v3, 4, v10
    v_add_u32 v17, s70, v10
    s_mul_i32 s63, s55, 44
    s_lshl_b32 s58, s54, 2
    s_add_u32 s63, s63, s58
    s_add_u32 s63, s63, s6
    s_lshl_b32 s63, s63, 10
    s_add_u32 s63, s63, 917504
    v_mov_b32 v56, -1
    v_mov_b32 v57, -1
    v_mov_b32 v58, -1
    v_mov_b32 v59, -1
    buffer_store_dwordx4 v[56:59], v4, s[44:47], s63 offen sc1
    s_cmp_eq_u32 s54, 10
    s_cselect_b32 s58, s6, 0
    s_cmp_eq_u32 s58, 3
    s_cselect_b32 s64, 0, -1
    v_and_b32 v11, 4, v1
    v_cmp_ne_u32 s[72:73], 0, v11
    s_mov_b32 s74, 0x01000100
    s_mov_b32 s75, 0x03020302
    s_barrier
    s_barrier
    s_barrier
    s_barrier
    s_barrier
    s_mov_b32 s59, 0
    s_add_u32 m0, s70, 0
    s_add_u32 s58, s5, 0
    buffer_load_dwordx4 v16, s[44:47], s58 offen sc1 lds
    s_add_u32 m0, s70, 1024
    s_add_u32 s58, s5, 4096
    buffer_load_dwordx4 v16, s[44:47], s58 offen sc1 lds
    s_add_u32 m0, s70, 2048
    s_add_u32 s58, s5, 8192
    buffer_load_dwordx4 v16, s[44:47], s58 offen sc1 lds
    s_add_u32 m0, s70, 3072
    s_add_u32 s58, s5, 12288
    buffer_load_dwordx4 v16, s[44:47], s58 offen sc1 lds
    buffer_load_dwordx4 v[224:227], v5, s[40:43], s62 offen offset:0 nt
    buffer_load_dwordx4 v[228:231], v5, s[40:43], s62 offen offset:1024 nt
    buffer_load_dwordx4 v[232:235], v5, s[40:43], s62 offen offset:2048 nt
    buffer_load_dwordx4 v[236:239], v5, s[40:43], s62 offen offset:3072 nt
    s_add_u32 s62, s62, 4096
    buffer_load_dwordx4 v[240:243], v5, s[40:43], s62 offen offset:0 nt
    buffer_load_dwordx4 v[244:247], v5, s[40:43], s62 offen offset:1024 nt
    buffer_load_dwordx4 v[248:251], v5, s[40:43], s62 offen offset:2048 nt
    buffer_load_dwordx4 v[252:255], v5, s[40:43], s62 offen offset:3072 nt
    s_waitcnt vmcnt(8)
    s_branch L_hgf
L_hg:
    s_add_u32 m0, s70, 0
    s_add_u32 s58, s5, 0
    buffer_load_dwordx4 v16, s[44:47], s58 offen sc1 lds
    s_add_u32 m0, s70, 1024
    s_add_u32 s58, s5, 4096
    buffer_load_dwordx4 v16, s[44:47], s58 offen sc1 lds
    s_add_u32 m0, s70, 2048
    s_add_u32 s58, s5, 8192
    buffer_load_dwordx4 v16, s[44:47], s58 offen sc1 lds
    s_add_u32 m0, s70, 3072
    s_add_u32 s58, s5, 12288
    buffer_load_dwordx4 v16, s[44:47], s58 offen sc1 lds
    s_waitcnt vmcnt(0)
L_hgf:
    ds_read_b128 v[64:67], v17 offset:0
    ds_read_b128 v[68:71], v17 offset:1024
    ds_read_b128 v[72:75], v17 offset:2048
    ds_read_b128 v[76:79], v17 offset:3072
    s_waitcnt lgkmcnt(0)
    v_xor_b32 v11, s4, v66
    v_xor_b32 v12, s4, v70
    v_xor_b32 v13, s4, v74
    v_xor_b32 v14, s4, v78
    v_or3_b32 v11, v11, v12, v13
    v_or_b32 v11, v11, v14
    v_cmp_ne_u32 vcc, 0, v11
    s_cmp_eq_u64 vcc, 0
    s_cbranch_scc1 L_hg_ok
    s_add_u32 s59, s59, 1
    s_cmp_lt_u32 s59, 60000
    s_cbranch_scc1 L_hg
L_hg_ok:
    v_lshlrev_b32 v32, 16, v64
    v_and_b32 v33, 0xffff0000, v64
    v_lshlrev_b32 v34, 16, v65
    v_and_b32 v35, 0xffff0000, v65
    v_lshlrev_b32 v36, 16, v68
    v_and_b32 v37, 0xffff0000, v68
    v_lshlrev_b32 v38, 16, v69
    v_and_b32 v39, 0xffff0000, v69
    v_lshlrev_b32 v40, 16, v72
    v_and_b32 v41, 0xffff0000, v72
    v_lshlrev_b32 v42, 16, v73
    v_and_b32 v43, 0xffff0000, v73
    v_lshlrev_b32 v44, 16, v76
    v_and_b32 v45, 0xffff0000, v76
    v_lshlrev_b32 v46, 16, v77
    v_and_b32 v47, 0xffff0000, v77
    v_add_f32 v32, v32, v36
    v_add_f32 v40, v40, v44
    v_add_f32 v33, v33, v37
    v_add_f32 v41, v41, v45
    v_add_f32 v34, v34, v38
    v_add_f32 v42, v42, v46
    v_add_f32 v35, v35, v39
    v_add_f32 v43, v43, v47
    v_add_f32_dpp v32, v32, v32 quad_perm:[1,0,3,2] row_mask:0xf bank_mask:0xf
    v_add_f32_dpp v33, v33, v33 quad_perm:[1,0,3,2] row_mask:0xf bank_mask:0xf
    v_add_f32_dpp v34, v34, v34 quad_perm:[1,0,3,2] row_mask:0xf bank_mask:0xf
    v_add_f32_dpp v35, v35, v35 quad_perm:[1,0,3,2] row_mask:0xf bank_mask:0xf
    v_add_f32_dpp v40, v40, v40 quad_perm:[1,0,3,2] row_mask:0xf bank_mask:0xf
    v_add_f32_dpp v41, v41, v41 quad_perm:[1,0,3,2] row_mask:0xf bank_mask:0xf
    v_add_f32_dpp v42, v42, v42 quad_perm:[1,0,3,2] row_mask:0xf bank_mask:0xf
    v_add_f32_dpp v43, v43, v43 quad_perm:[1,0,3,2] row_mask:0xf bank_mask:0xf
    v_add_f32_dpp v32, v32, v32 quad_perm:[2,3,0,1] row_mask:0xf bank_mask:0xf
    v_add_f32_dpp v33, v33, v33 quad_perm:[2,3,0,1] row_mask:0xf bank_mask:0xf
    v_add_f32_dpp v34, v34, v34 quad_perm:[2,3,0,1] row_mask:0xf bank_mask:0xf
    v_add_f32_dpp v35, v35, v35 quad_perm:[2,3,0,1] row_mask:0xf bank_mask:0xf
    v_add_f32_dpp v40, v40, v40 quad_perm:[2,3,0,1] row_mask:0xf bank_mask:0xf
    v_add_f32_dpp v41, v41, v41 quad_perm:[2,3,0,1] row_mask:0xf bank_mask:0xf
    v_add_f32_dpp v42, v42, v42 quad_perm:[2,3,0,1] row_mask:0xf bank_mask:0xf
    v_add_f32_dpp v43, v43, v43 quad_perm:[2,3,0,1] row_mask:0xf bank_mask:0xf
    v_cvt_pk_bf16_f32 v32, v32, v32
    v_cvt_pk_bf16_f32 v33, v33, v33
    v_cvt_pk_bf16_f32 v34, v34, v34
    v_cvt_pk_bf16_f32 v35, v35, v35
    v_cvt_pk_bf16_f32 v40, v40, v40
    v_cvt_pk_bf16_f32 v41, v41, v41
    v_cvt_pk_bf16_f32 v42, v42, v42
    v_cvt_pk_bf16_f32 v43, v43, v43
    v_and_b32 v32, 0xffff0000, v32
    v_and_b32 v33, 0xffff0000, v33
    v_and_b32 v34, 0xffff0000, v34
    v_and_b32 v35, 0xffff0000, v35
    v_and_b32 v40, 0xffff0000, v40
    v_and_b32 v41, 0xffff0000, v41
    v_and_b32 v42, 0xffff0000, v42
    v_and_b32 v43, 0xffff0000, v43
    v_mul_f32 v36, 0xbfb8aa3b, v32
    v_mul_f32 v37, 0xbfb8aa3b, v33
    v_mul_f32 v38, 0xbfb8aa3b, v34
    v_mul_f32 v39, 0xbfb8aa3b, v35
    v_exp_f32 v36, v36
    v_exp_f32 v37, v37
    v_exp_f32 v38, v38
    v_exp_f32 v39, v39
    v_add_f32 v36, 1.0, v36
    v_add_f32 v37, 1.0, v37
    v_add_f32 v38, 1.0, v38
    v_add_f32 v39, 1.0, v39
    v_rcp_f32 v36, v36
    v_rcp_f32 v37, v37
    v_rcp_f32 v38, v38
    v_rcp_f32 v39, v39
    v_mul_f32 v32, v32, v36
    v_mul_f32 v33, v33, v37
    v_mul_f32 v34, v34, v38
    v_mul_f32 v35, v35, v39
    v_cvt_pk_bf16_f32 v32, v32, v32
    v_cvt_pk_bf16_f32 v33, v33, v33
    v_cvt_pk_bf16_f32 v34, v34, v34
    v_cvt_pk_bf16_f32 v35, v35, v35
    v_and_b32 v32, 0xffff0000, v32
    v_and_b32 v33, 0xffff0000, v33
    v_and_b32 v34, 0xffff0000, v34
    v_and_b32 v35, 0xffff0000, v35
    v_mul_f32 v32, v32, v40
    v_mul_f32 v33, v33, v41
    v_mul_f32 v34, v34, v42
    v_mul_f32 v35, v35, v43
    v_cvt_pk_bf16_f32 v32, v32, v33
    v_cvt_pk_bf16_f32 v33, v34, v35
    v_and_b32 v32, s64, v32
    v_and_b32 v33, s64, v33
    s_nop 0
    v_mov_b32_dpp v34, v32 row_half_mirror row_mask:0xf bank_mask:0xf
    v_mov_b32_dpp v35, v33 row_half_mirror row_mask:0xf bank_mask:0xf
    v_cndmask_b32 v36, v32, v34, s[72:73]
    v_cndmask_b32 v37, v33, v35, s[72:73]
    v_cndmask_b32 v38, v34, v32, s[72:73]
    v_cndmask_b32 v39, v35, v33, s[72:73]
    v_perm_b32 v40, v36, v36, s74
    v_perm_b32 v41, v36, v36, s75
    v_perm_b32 v42, v37, v37, s74
    v_perm_b32 v43, v37, v37, s75
    v_perm_b32 v44, v38, v38, s74
    v_perm_b32 v45, v38, v38, s75
    v_perm_b32 v46, v39, v39, s74
    v_perm_b32 v47, v39, v39, s75
    s_waitcnt vmcnt(0)
    v_and_b32 v128, v40, v6
    v_and_b32 v129, v40, v7
    v_and_b32 v130, v40, v8
    v_and_b32 v131, v40, v9
    v_and_b32 v132, v41, v6
    v_and_b32 v133, v41, v7
    v_and_b32 v134, v41, v8
    v_and_b32 v135, v41, v9
    v_mfma_f32_16x16x32_bf16 v[12:15], v[128:131], v[224:227], 0
    v_and_b32 v136, v42, v6
    v_and_b32 v137, v42, v7
    v_and_b32 v138, v42, v8
    v_and_b32 v139, v42, v9
    v_mfma_f32_16x16x32_bf16 v[12:15], v[132:135], v[228:231], v[12:15]
    v_and_b32 v140, v43, v6
    v_and_b32 v141, v43, v7
    v_and_b32 v142, v43, v8
    v_and_b32 v143, v43, v9
    v_mfma_f32_16x16x32_bf16 v[12:15], v[136:139], v[232:235], v[12:15]
    v_and_b32 v144, v44, v6
    v_and_b32 v145, v44, v7
    v_and_b32 v146, v44, v8
    v_and_b32 v147, v44, v9
    v_mfma_f32_16x16x32_bf16 v[12:15], v[140:143], v[236:239], v[12:15]
    v_and_b32 v148, v45, v6
    v_and_b32 v149, v45, v7
    v_and_b32 v150, v45, v8
    v_and_b32 v151, v45, v9
    v_mfma_f32_16x16x32_bf16 v[12:15], v[144:147], v[240:243], v[12:15]
    v_and_b32 v152, v46, v6
    v_and_b32 v153, v46, v7
    v_and_b32 v154, v46, v8
    v_and_b32 v155, v46, v9
    v_mfma_f32_16x16x32_bf16 v[12:15], v[148:151], v[244:247], v[12:15]
    v_and_b32 v156, v47, v6
    v_and_b32 v157, v47, v7
    v_and_b32 v158, v47, v8
    v_and_b32 v159, v47, v9
    v_mfma_f32_16x16x32_bf16 v[12:15], v[152:155], v[248:251], v[12:15]
    s_nop 0
    v_mfma_f32_16x16x32_bf16 v[12:15], v[156:159], v[252:255], v[12:15]
    s_nop 7
    v_cvt_pk_bf16_f32 v12, v12, v13
    v_cvt_pk_bf16_f32 v13, v14, v15
    v_mov_b32 v14, s4
    v_mov_b32 v15, 0
    buffer_store_dwordx4 v[12:15], v4, s[44:47], s63 offen sc1
    s_branch L_fin
L_R:
    s_sub_u32 s54, s68, 28
    v_and_b32 v10, 1, v1
    v_cmp_ne_u32 s[72:73], 0, v10
    v_and_b32 v10, 2, v1
    v_cmp_ne_u32 s[74:75], 0, v10
    v_cmp_gt_u32 s[76:77], 4, v2
    s_lshl_b32 s62, s54, 8
    s_lshl_b32 s58, s55, 6
    s_add_u32 s62, s62, s58
    v_lshrrev_b32 v10, 3, v2
    v_lshlrev_b32 v18, 10, v10
    v_and_b32 v11, 3, v2
    v_lshl_add_u32 v18, v11, 4, v18
    v_bfe_u32 v10, v2, 2, 1
    v_lshl_add_u32 v18, v10, 3, v18
    v_lshrrev_b32 v10, 2, v2
    v_lshlrev_b32 v17, 8, v10
    v_lshl_add_u32 v17, v11, 4, v17
    v_lshl_add_u32 v17, v3, 10, v17
    v_lshlrev_b32 v16, 4, v2
    v_lshl_add_u32 v16, v3, 10, v16
    buffer_load_dwordx2 v[20:21], v18, s[8:11], s62 offen
    v_mov_b32 v10, 0x3f803f80
    v_and_b32 v24, v10, v6
    v_cndmask_b32 v24, 0, v24, s[76:77]
    v_and_b32 v25, v10, v7
    v_cndmask_b32 v25, 0, v25, s[76:77]
    v_and_b32 v26, v10, v8
    v_cndmask_b32 v26, 0, v26, s[76:77]
    v_and_b32 v27, v10, v9
    v_cndmask_b32 v27, 0, v27, s[76:77]
    s_mul_i32 s5, s54, 45056
    s_lshl_b32 s58, s55, 6
    s_add_u32 s5, s5, s58
    s_add_u32 s5, s5, 917504
    s_lshl_b32 s58, s55, 8
    s_lshl_b32 s6, s54, 15
    s_add_u32 s6, s6, s58
    s_add_u32 s6, s6, 589824
    s_add_u32 s80, s6, 4096
    s_add_u32 s81, s6, 8192
    s_add_u32 s82, s6, 12288
    s_add_u32 s83, s6, 16384
    s_add_u32 s84, s6, 20480
    s_add_u32 s85, s6, 24576
    s_add_u32 s86, s6, 28672
    v_cmp_gt_u32 s[78:79], 16, v1
    s_waitcnt vmcnt(0)
    v_lshlrev_b32 v40, 16, v20
    v_and_b32 v41, 0xffff0000, v20
    v_lshlrev_b32 v42, 16, v21
    v_and_b32 v43, 0xffff0000, v21
    s_barrier
    buffer_store_dwordx4 v[52:55], v4, s[44:47], s69 offen sc1
    s_barrier
    s_barrier
    s_barrier
    buffer_load_dwordx4 v[56:59], v61, s[28:31], s87 offen
    s_add_u32 s87, s87, 4096
    buffer_load_dwordx4 v[56:59], v61, s[28:31], s87 offen
    s_add_u32 s87, s87, 4096
    buffer_load_dwordx4 v[56:59], v61, s[28:31], s87 offen
    s_add_u32 s87, s87, 4096
    buffer_load_dwordx4 v[56:59], v61, s[28:31], s87 offen
    s_add_u32 s87, s87, 4096
    buffer_load_dwordx4 v[56:59], v61, s[28:31], s87 offen
    s_add_u32 s87, s87, 4096
    buffer_load_dwordx4 v[56:59], v61, s[28:31], s87 offen
    s_add_u32 s87, s87, 4096
    buffer_load_dwordx4 v[56:59], v61, s[28:31], s87 offen
    s_add_u32 s87, s87, 4096
    buffer_load_dwordx4 v[56:59], v61, s[28:31], s87 offen
    s_add_u32 s87, s87, 4096
    buffer_load_dwordx4 v[56:59], v61, s[28:31], s87 offen
    s_add_u32 s87, s87, 4096
    buffer_load_dwordx4 v[56:59], v61, s[28:31], s87 offen
    s_add_u32 s87, s87, 4096
    buffer_load_dwordx4 v[56:59], v61, s[28:31], s87 offen
    s_add_u32 s87, s87, 4096
    buffer_load_dwordx4 v[56:59], v61, s[28:31], s87 offen
    s_add_u32 s87, s87, 4096
    buffer_load_dwordx4 v[56:59], v61, s[28:31], s87 offen
    s_add_u32 s87, s87, 4096
    buffer_load_dwordx4 v[56:59], v61, s[28:31], s87 offen
    s_add_u32 s87, s87, 4096
    buffer_load_dwordx4 v[56:59], v61, s[28:31], s87 offen
    s_add_u32 s87, s87, 4096
    buffer_load_dwordx4 v[56:59], v61, s[28:31], s87 offen
    s_add_u32 s87, s87, 4096
    s_barrier
    v_add_u32 v19, 150016, v4
    s_cmp_eq_u32 s3, 0
    s_cbranch_scc1 L_R5
    s_sleep 56
    s_mov_b32 s59, 0
L_hf:
    s_add_u32 s58, s5, 0
    buffer_load_dwordx4 v[64:67], v17, s[44:47], s58 offen sc1
    s_add_u32 s58, s5, 4096
    buffer_load_dwordx4 v[68:71], v17, s[44:47], s58 offen sc1
    s_add_u32 s58, s5, 8192
    buffer_load_dwordx4 v[72:75], v17, s[44:47], s58 offen sc1
    s_add_u32 s58, s5, 12288
    buffer_load_dwordx4 v[76:79], v17, s[44:47], s58 offen sc1
    s_add_u32 s58, s5, 16384
    buffer_load_dwordx4 v[80:83], v17, s[44:47], s58 offen sc1
    s_add_u32 s58, s5, 20480
    buffer_load_dwordx4 v[84:87], v17, s[44:47], s58 offen sc1
    s_add_u32 s58, s5, 24576
    buffer_load_dwordx4 v[88:91], v17, s[44:47], s58 offen sc1
    s_add_u32 s58, s5, 28672
    buffer_load_dwordx4 v[92:95], v17, s[44:47], s58 offen sc1
    s_add_u32 s58, s5, 32768
    buffer_load_dwordx4 v[96:99], v17, s[44:47], s58 offen sc1
    s_add_u32 s58, s5, 36864
    buffer_load_dwordx4 v[100:103], v17, s[44:47], s58 offen sc1
    s_add_u32 s58, s5, 40960
    buffer_load_dwordx4 v[104:107], v17, s[44:47], s58 offen sc1
    s_waitcnt vmcnt(10)
    v_mfma_f32_16x16x32_bf16 v[32:35], v[24:27], v[64:67], 0
    v_xor_b32 v12, s4, v66
    s_waitcnt vmcnt(9)
    v_mfma_f32_16x16x32_bf16 v[32:35], v[24:27], v[68:71], v[32:35]
    v_xor_b32 v13, s4, v70
    v_or_b32 v12, v12, v13
    s_waitcnt vmcnt(8)
    v_mfma_f32_16x16x32_bf16 v[32:35], v[24:27], v[72:75], v[32:35]
    v_xor_b32 v13, s4, v74
    v_or_b32 v12, v12, v13
    s_waitcnt vmcnt(7)
    v_mfma_f32_16x16x32_bf16 v[32:35], v[24:27], v[76:79], v[32:35]
    v_xor_b32 v13, s4, v78
    v_or_b32 v12, v12, v13
    s_waitcnt vmcnt(6)
    v_mfma_f32_16x16x32_bf16 v[32:35], v[24:27], v[80:83], v[32:35]
    v_xor_b32 v13, s4, v82
    v_or_b32 v12, v12, v13
    s_waitcnt vmcnt(5)
    v_mfma_f32_16x16x32_bf16 v[32:35], v[24:27], v[84:87], v[32:35]
    v_xor_b32 v13, s4, v86
    v_or_b32 v12, v12, v13
    s_waitcnt vmcnt(4)
    v_mfma_f32_16x16x32_bf16 v[32:35], v[24:27], v[88:91], v[32:35]
    v_xor_b32 v13, s4, v90
    v_or_b32 v12, v12, v13
    s_waitcnt vmcnt(3)
    v_mfma_f32_16x16x32_bf16 v[32:35], v[24:27], v[92:95], v[32:35]
    v_xor_b32 v13, s4, v94
    v_or_b32 v12, v12, v13
    s_waitcnt vmcnt(2)
    v_mfma_f32_16x16x32_bf16 v[32:35], v[24:27], v[96:99], v[32:35]
    v_xor_b32 v13, s4, v98
    v_or_b32 v12, v12, v13
    s_waitcnt vmcnt(1)
    v_mfma_f32_16x16x32_bf16 v[32:35], v[24:27], v[100:103], v[32:35]
    v_xor_b32 v13, s4, v102
    v_or_b32 v12, v12, v13
    s_waitcnt vmcnt(0)
    v_mfma_f32_16x16x32_bf16 v[32:35], v[24:27], v[104:107], v[32:35]
    v_xor_b32 v13, s4, v106
    v_or_b32 v12, v12, v13
    v_cmp_ne_u32 vcc, 0, v12
    s_cmp_eq_u64 vcc, 0
    s_cbranch_scc1 L_hf_ok
    s_sleep 1
    s_add_u32 s59, s59, 1
    s_cmp_lt_u32 s59, 60000
    s_cbranch_scc1 L_hf
L_hf_ok:
    s_nop 3
    v_cvt_pk_bf16_f32 v32, v32, v32
    v_cvt_pk_bf16_f32 v33, v33, v33
    v_cvt_pk_bf16_f32 v34, v34, v34
    v_cvt_pk_bf16_f32 v35, v35, v35
    v_and_b32 v32, 0xffff0000, v32
    v_and_b32 v33, 0xffff0000, v33
    v_and_b32 v34, 0xffff0000, v34
    v_and_b32 v35, 0xffff0000, v35
    v_mul_f32 v36, 0xbfb8aa3b, v32
    v_mul_f32 v37, 0xbfb8aa3b, v33
    v_mul_f32 v38, 0xbfb8aa3b, v34
    v_mul_f32 v39, 0xbfb8aa3b, v35
    v_exp_f32 v36, v36
    v_exp_f32 v37, v37
    v_exp_f32 v38, v38
    v_exp_f32 v39, v39
    v_add_f32 v36, 1.0, v36
    v_add_f32 v37, 1.0, v37
    v_add_f32 v38, 1.0, v38
    v_add_f32 v39, 1.0, v39
    v_rcp_f32 v36, v36
    v_rcp_f32 v37, v37
    v_rcp_f32 v38, v38
    v_rcp_f32 v39, v39
    v_mul_f32 v32, v32, v36
    v_mul_f32 v33, v33, v37
    v_mul_f32 v34, v34, v38
    v_mul_f32 v35, v35, v39
    v_cvt_pk_bf16_f32 v32, v32, v32
    v_cvt_pk_bf16_f32 v33, v33, v33
    v_cvt_pk_bf16_f32 v34, v34, v34
    v_cvt_pk_bf16_f32 v35, v35, v35
    v_and_b32 v32, 0xffff0000, v32
    v_and_b32 v33, 0xffff0000, v33
    v_and_b32 v34, 0xffff0000, v34
    v_and_b32 v35, 0xffff0000, v35
    ds_write_b128 v19, v[32:35]
    s_waitcnt lgkmcnt(0)
    s_barrier
    s_branch L_fin
L_R5:
    s_sleep 66
    s_mov_b32 s59, 0
L_h5:
    buffer_load_dwordx4 v[64:67], v16, s[44:47], s6 offen sc1
    buffer_load_dwordx4 v[68:71], v16, s[44:47], s80 offen sc1
    buffer_load_dwordx4 v[72:75], v16, s[44:47], s81 offen sc1
    buffer_load_dwordx4 v[76:79], v16, s[44:47], s82 offen sc1
    buffer_load_dwordx4 v[80:83], v16, s[44:47], s83 offen sc1
    buffer_load_dwordx4 v[84:87], v16, s[44:47], s84 offen sc1
    buffer_load_dwordx4 v[88:91], v16, s[44:47], s85 offen sc1
    buffer_load_dwordx4 v[92:95], v16, s[44:47], s86 offen sc1
    s_waitcnt vmcnt(7)
    v_mfma_f32_16x16x32_bf16 v[44:47], v[24:27], v[64:67], 0
    v_xor_b32 v12, s4, v66
    s_waitcnt vmcnt(6)
    v_mfma_f32_16x16x32_bf16 v[48:51], v[24:27], v[68:71], 0
    v_xor_b32 v13, s4, v70
    v_or_b32 v12, v12, v13
    s_waitcnt vmcnt(5)
    v_mfma_f32_16x16x32_bf16 v[44:47], v[24:27], v[72:75], v[44:47]
    v_xor_b32 v13, s4, v74
    v_or_b32 v12, v12, v13
    s_waitcnt vmcnt(4)
    v_mfma_f32_16x16x32_bf16 v[48:51], v[24:27], v[76:79], v[48:51]
    v_xor_b32 v13, s4, v78
    v_or_b32 v12, v12, v13
    s_waitcnt vmcnt(3)
    v_mfma_f32_16x16x32_bf16 v[44:47], v[24:27], v[80:83], v[44:47]
    v_xor_b32 v13, s4, v82
    v_or_b32 v12, v12, v13
    s_waitcnt vmcnt(2)
    v_mfma_f32_16x16x32_bf16 v[48:51], v[24:27], v[84:87], v[48:51]
    v_xor_b32 v13, s4, v86
    v_or_b32 v12, v12, v13
    s_waitcnt vmcnt(1)
    v_mfma_f32_16x16x32_bf16 v[44:47], v[24:27], v[88:91], v[44:47]
    v_xor_b32 v13, s4, v90
    v_or_b32 v12, v12, v13
    s_waitcnt vmcnt(0)
    v_mfma_f32_16x16x32_bf16 v[48:51], v[24:27], v[92:95], v[48:51]
    v_xor_b32 v13, s4, v94
    v_or_b32 v12, v12, v13
    v_cmp_ne_u32 vcc, 0, v12
    s_cmp_eq_u64 vcc, 0
    s_cbranch_scc1 L_h5_ok
    s_add_u32 s59, s59, 1
    s_cmp_lt_u32 s59, 60000
    s_cbranch_scc1 L_h5
L_h5_ok:
    s_barrier
    ds_read_b128 v[32:35], v19
    s_nop 1
    v_add_f32 v44, v44, v48
    v_add_f32 v45, v45, v49
    v_add_f32 v46, v46, v50
    v_add_f32 v47, v47, v51
    v_cvt_pk_bf16_f32 v44, v44, v44
    v_cvt_pk_bf16_f32 v45, v45, v45
    v_cvt_pk_bf16_f32 v46, v46, v46
    v_cvt_pk_bf16_f32 v47, v47, v47
    v_and_b32 v44, 0xffff0000, v44
    v_and_b32 v45, 0xffff0000, v45
    v_and_b32 v46, 0xffff0000, v46
    v_and_b32 v47, 0xffff0000, v47
    s_waitcnt lgkmcnt(0)
    v_mul_f32 v44, v44, v32
    v_mul_f32 v45, v45, v33
    v_mul_f32 v46, v46, v34
    v_mul_f32 v47, v47, v35
    v_cvt_pk_bf16_f32 v44, v44, v44
    v_cvt_pk_bf16_f32 v45, v45, v45
    v_cvt_pk_bf16_f32 v46, v46, v46
    v_cvt_pk_bf16_f32 v47, v47, v47
    v_and_b32 v44, 0xffff0000, v44
    v_and_b32 v45, 0xffff0000, v45
    v_and_b32 v46, 0xffff0000, v46
    v_and_b32 v47, 0xffff0000, v47
    v_add_f32 v44, v44, v40
    v_add_f32 v45, v45, v41
    v_add_f32 v46, v46, v42
    v_add_f32 v47, v47, v43
    v_cvt_pk_bf16_f32 v44, v44, v45
    v_cvt_pk_bf16_f32 v45, v46, v47
    s_mov_b64 exec, s[78:79]
    buffer_store_dwordx2 v[44:45], v18, s[48:51], s62 offen sc0 sc1
    s_mov_b64 exec, -1
    s_or_b32 s58, s54, s55
    s_cmp_lg_u32 s58, 0
    s_cbranch_scc1 L_noep
    v_mov_b32 v10, 0
    v_mov_b32 v11, s7
    s_mov_b64 exec, 1
    buffer_store_dword v11, v10, s[44:47], 0 offen sc1
    s_mov_b64 exec, -1
L_noep:
    s_branch L_fin
L_S:
    s_lshl_b32 s68, s68, 3
    s_add_u32 s68, s68, s52
    s_lshr_b32 s58, s2, 4
    s_lshl_b32 s56, s52, 4
    s_add_u32 s56, s56, s58
    s_mul_i32 s58, s52, 3
    s_max_u32 s59, s52, 6
    s_sub_u32 s58, s58, s59
    s_add_u32 s58, s58, 6
    s_lshr_b32 s59, s68, 3
    s_add_u32 s58, s58, s59
    s_lshl_b32 s59, s58, 1
    s_cmp_ge_u32 s58, 11
    s_cselect_b32 s58, 21, 0
    s_sub_u32 s59, s59, s58
    s_cmp_lt_u32 s68, 22
    s_cselect_b32 s68, s59, s68
    s_lshl_b32 s66, s3, 15
    s_lshl_b32 s67, s56, 17
    s_add_u32 s67, s67, s66
    s_mov_b32 s85, 0
    v_mov_b32 v14, 155648
    v_mov_b32 v15, 0
    ds_write_b32 v14, v15
    s_waitcnt lgkmcnt(0)
    s_add_u32 s7, s4, 1
    s_lshl_b32 s4, s7, 2
    s_and_b32 s4, s4, 0x3fff0000
    s_and_b32 s58, s7, 0x3fff
    s_or_b32 s4, s4, s58
    s_lshr_b32 s58, s56, 6
    s_lshl_b32 s62, s58, 15
    s_lshl_b32 s63, s57, 14
    s_add_u32 s62, s62, s63
    s_lshl_b32 s64, s3, 12
    s_add_u32 s62, s62, s64
    s_add_u32 s62, s62, 327680
    s_add_u32 s64, s64, 131072
    s_lshl_b32 s63, s57, 15
    s_lshl_b32 s58, s58, 7
    s_add_u32 s63, s63, s58
    s_and_b32 s58, s3, 1
    s_lshl_b32 s58, s58, 8
    s_add_u32 s63, s63, s58
    s_add_u32 s63, s63, 393216
    s_lshl_b32 s58, s58, 2
    s_add_u32 s70, s58, 147456
    s_lshr_b32 s63, s56, 6
    s_lshl_b32 s63, s63, 11
    s_lshl_b32 s58, s57, 10
    s_add_u32 s63, s63, s58
    s_lshr_b32 s58, s3, 1
    s_lshl_b32 s58, s58, 9
    s_add_u32 s63, s63, s58
    s_and_b32 s58, s3, 1
    s_lshl_b32 s58, s58, 2
    s_add_u32 s63, s63, s58
    s_add_u32 s63, s63, 393216
    v_lshlrev_b32 v20, 3, v1
    s_and_b32 s58, s3, 1
    s_lshl_b32 s58, s58, 7
    s_lshr_b32 s59, s3, 1
    s_lshl_b32 s59, s59, 4
    s_or_b32 s58, s58, s59
    v_xor_b32 v16, s58, v4
    v_xor_b32 v17, 32, v16
    v_xor_b32 v18, 64, v16
    v_xor_b32 v19, 96, v16
    s_cmp_ge_u32 s3, 2
    s_cselect_b32 s86, 0, -1
    s_cselect_b32 s87, -1, 0
    v_and_b32 v10, 7, v2
    v_lshlrev_b32 v10, 1, v10
    v_lshrrev_b32 v11, 3, v2
    v_or_b32 v10, v10, v11
    v_lshlrev_b32 v10, 4, v10
    v_lshl_add_u32 v10, v3, 8, v10
    v_lshl_add_u32 v10, v2, 10, v10
    v_add_u32 v21, s66, v10
    v_add_u32 v22, 131072, v10
    s_lshl_b32 s58, s3, 6
    v_xor_b32 v21, s58, v21
    v_xor_b32 v22, s58, v22
    v_xor_b32 v23, 0x4000, v21
    v_xor_b32 v240, 0, v22
    v_xor_b32 v224, 0, v23
    v_xor_b32 v241, 16, v22
    v_xor_b32 v225, 16, v23
    v_xor_b32 v242, 32, v22
    v_xor_b32 v226, 32, v23
    v_xor_b32 v243, 48, v22
    v_xor_b32 v227, 48, v23
    v_xor_b32 v244, 64, v22
    v_xor_b32 v228, 64, v23
    v_xor_b32 v245, 80, v22
    v_xor_b32 v229, 80, v23
    v_xor_b32 v246, 96, v22
    v_xor_b32 v230, 96, v23
    v_xor_b32 v247, 112, v22
    v_xor_b32 v231, 112, v23
    v_xor_b32 v248, 128, v22
    v_xor_b32 v232, 128, v23
    v_xor_b32 v249, 144, v22
    v_xor_b32 v233, 144, v23
    v_xor_b32 v250, 160, v22
    v_xor_b32 v234, 160, v23
    v_xor_b32 v251, 176, v22
    v_xor_b32 v235, 176, v23
    v_xor_b32 v252, 192, v22
    v_xor_b32 v236, 192, v23
    v_xor_b32 v253, 208, v22
    v_xor_b32 v237, 208, v23
    v_xor_b32 v254, 224, v22
    v_xor_b32 v238, 224, v23
    v_xor_b32 v255, 240, v22
    v_xor_b32 v239, 240, v23
    v_lshrrev_b32 v10, 2, v2
    v_lshl_add_u32 v10, v3, 2, v10
    v_and_b32 v11, 7, v10
    v_lshlrev_b32 v11, 1, v11
    v_lshrrev_b32 v12, 3, v10
    v_or_b32 v11, v11, v12
    v_bfe_u32 v12, v2, 1, 1
    v_xor_b32 v11, v11, v12
    v_lshlrev_b32 v11, 4, v11
    v_and_b32 v12, 1, v2
    v_lshl_add_u32 v11, v12, 3, v11
    v_lshl_add_u32 v23, v10, 10, v11
    s_lshl_b32 s58, s3, 8
    v_add_u32 v23, s58, v23
    v_xor_b32 v192, 0, v23
    v_xor_b32 v200, 16384, v23
    v_xor_b32 v193, 32, v23
    v_xor_b32 v201, 16416, v23
    v_xor_b32 v194, 64, v23
    v_xor_b32 v202, 16448, v23
    v_xor_b32 v195, 96, v23
    v_xor_b32 v203, 16480, v23
    v_xor_b32 v196, 128, v23
    v_xor_b32 v204, 16512, v23
    v_xor_b32 v197, 160, v23
    v_xor_b32 v205, 16544, v23
    v_xor_b32 v198, 192, v23
    v_xor_b32 v206, 16576, v23
    v_xor_b32 v199, 224, v23
    v_xor_b32 v207, 16608, v23
    v_add_u32 v208, 0x10000, v192
    v_add_u32 v209, 0x10000, v193
    v_add_u32 v210, 0x10000, v194
    v_add_u32 v211, 0x10000, v195
    v_add_u32 v212, 0x10000, v196
    v_add_u32 v213, 0x10000, v197
    v_add_u32 v214, 0x10000, v198
    v_add_u32 v215, 0x10000, v199
    v_add_u32 v216, 0x10000, v200
    v_add_u32 v217, 0x10000, v201
    v_add_u32 v218, 0x10000, v202
    v_add_u32 v219, 0x10000, v203
    v_add_u32 v220, 0x10000, v204
    v_add_u32 v221, 0x10000, v205
    v_add_u32 v222, 0x10000, v206
    v_add_u32 v223, 0x10000, v207
    v_lshlrev_b32 v42, 2, v2
    s_lshl_b32 s58, s3, 6
    v_add_u32 v42, 149504, v42
    v_add_u32 v43, s58, v42
    s_lshl_b32 s58, s3, 10
    v_add_u32 v44, 150016, v4
    v_add_u32 v45, s58, v44
    v_and_b32 v10, 3, v2
    v_lshl_add_u32 v46, v3, 2, v10
    v_lshlrev_b32 v47, 4, v46
    v_lshlrev_b32 v46, 2, v46
    v_add_u32 v46, 149504, v46
    v_lshlrev_b32 v48, 4, v2
    v_lshl_add_u32 v48, v3, 19, v48
    v_and_b32 v10, 1, v1
    v_cmp_ne_u32 s[72:73], 0, v10
    v_and_b32 v10, 2, v1
    v_cmp_ne_u32 s[74:75], 0, v10
    v_cmp_gt_u32 s[76:77], 4, v2
    v_mov_b32 v52, 0x3f803f80
    v_mov_b32 v53, v52
    v_mov_b32 v54, v52
    v_mov_b32 v55, v52
    v_mov_b32 v63, s4
    s_lshl_b32 s78, s56, 8
    s_lshl_b32 s58, s57, 21
    s_add_u32 s78, s78, s58
    s_add_u32 s78, s78, s66
    s_lshl_b32 s59, s3, 8
    s_add_u32 s78, s78, 2097152
    s_add_u32 s80, s78, 131072
    s_add_u32 s81, s78, 262144
    s_add_u32 s82, s78, 393216
    s_lshl_b32 s58, s56, 8
    s_sub_u32 s78, s78, s58
    s_sub_u32 s80, s80, s58
    s_sub_u32 s81, s81, s58
    s_sub_u32 s82, s82, s58
    s_lshl_b32 s58, s57, 6
    s_add_u32 s58, s58, s3
    s_mul_i32 s58, s58, 17
    s_add_u32 s58, s58, s56
    v_mul_u32_u24 v10, 272, v3
    v_add_u32 v10, s58, v10
    v_add_u32 v11, 0, v10
    v_and_b32 v11, 127, v11
    v_lshl_add_u32 v28, v11, 8, v48
    v_add_u32 v11, 68, v10
    v_and_b32 v11, 127, v11
    v_lshl_add_u32 v29, v11, 8, v48
    v_add_u32 v11, 136, v10
    v_and_b32 v11, 127, v11
    v_lshl_add_u32 v30, v11, 8, v48
    v_add_u32 v11, 204, v10
    v_and_b32 v11, 127, v11
    v_lshl_add_u32 v31, v11, 8, v48
    v_lshlrev_b32 v47, 9, v47
    s_andn2_b32 s79, s56, 31
    s_and_b32 s58, s56, 3
    s_lshl_b32 s58, s58, 3
    s_or_b32 s79, s79, s58
    s_bfe_u32 s58, s56, 0x30002
    s_or_b32 s79, s79, s58
    s_lshl_b32 s79, s79, 4
    s_lshl_b32 s58, s57, 17
    s_add_u32 s79, s79, s58
    s_lshl_b32 s58, s3, 11
    s_add_u32 s79, s79, s58
    s_add_u32 s79, s79, 7340032
    s_lshr_b32 s58, s3, 1
    s_lshl_b32 s58, s58, 10
    s_and_b32 s59, s3, 1
    s_lshl_b32 s59, s59, 2
    s_add_u32 s58, s58, s59
    s_add_u32 s58, s58, 147456
    v_add_u32 v49, s58, v4
    v_mov_b32 v50, 0x7f800000
    s_barrier
    v_xor_b32 v11, 96, v4
    s_add_u32 m0, s66, 3072
    s_add_u32 s58, s67, 3072
    buffer_load_dwordx4 v11, s[12:15], s58 offen lds
    v_xor_b32 v11, 128, v4
    s_add_u32 m0, s66, 4096
    s_add_u32 s58, s67, 4096
    buffer_load_dwordx4 v11, s[12:15], s58 offen lds
    v_xor_b32 v11, 160, v4
    s_add_u32 m0, s66, 5120
    s_add_u32 s58, s67, 5120
    buffer_load_dwordx4 v11, s[12:15], s58 offen lds
    v_xor_b32 v11, 192, v4
    s_add_u32 m0, s66, 6144
    s_add_u32 s58, s67, 6144
    buffer_load_dwordx4 v11, s[12:15], s58 offen lds
    v_xor_b32 v11, 224, v4
    s_add_u32 m0, s66, 7168
    s_add_u32 s58, s67, 7168
    buffer_load_dwordx4 v11, s[12:15], s58 offen lds
    v_xor_b32 v11, 16, v4
    s_add_u32 m0, s66, 8192
    s_add_u32 s58, s67, 8192
    buffer_load_dwordx4 v11, s[12:15], s58 offen lds
    v_xor_b32 v11, 48, v4
    s_add_u32 m0, s66, 9216
    s_add_u32 s58, s67, 9216
    buffer_load_dwordx4 v11, s[12:15], s58 offen lds
    v_xor_b32 v11, 80, v4
    s_add_u32 m0, s66, 10240
    s_add_u32 s58, s67, 10240
    buffer_load_dwordx4 v11, s[12:15], s58 offen lds
    v_xor_b32 v11, 112, v4
    s_add_u32 m0, s66, 11264
    s_add_u32 s58, s67, 11264
    buffer_load_dwordx4 v11, s[12:15], s58 offen lds
    v_xor_b32 v11, 240, v4
    s_add_u32 m0, s66, 31744
    s_add_u32 s58, s67, 31744
    buffer_load_dwordx4 v11, s[12:15], s58 offen lds
    v_xor_b32 v11, 144, v4
    s_add_u32 m0, s66, 12288
    s_add_u32 s58, s67, 12288
    buffer_load_dwordx4 v11, s[12:15], s58 offen lds
    v_xor_b32 v11, 208, v4
    s_add_u32 m0, s66, 30720
    s_add_u32 s58, s67, 30720
    buffer_load_dwordx4 v11, s[12:15], s58 offen lds
    v_xor_b32 v11, 176, v4
    s_add_u32 m0, s66, 13312
    s_add_u32 s58, s67, 13312
    buffer_load_dwordx4 v11, s[12:15], s58 offen lds
    s_waitcnt vmcnt(15)
    v_xor_b32 v11, 176, v4
    s_add_u32 m0, s66, 29696
    s_add_u32 s58, s67, 29696
    buffer_load_dwordx4 v11, s[12:15], s58 offen lds
    s_waitcnt vmcnt(15)
    v_xor_b32 v11, 208, v4
    s_add_u32 m0, s66, 14336
    s_add_u32 s58, s67, 14336
    buffer_load_dwordx4 v11, s[12:15], s58 offen lds
    s_waitcnt vmcnt(15)
    v_xor_b32 v11, 144, v4
    s_add_u32 m0, s66, 28672
    s_add_u32 s58, s67, 28672
    buffer_load_dwordx4 v11, s[12:15], s58 offen lds
    s_waitcnt vmcnt(15)
    v_xor_b32 v11, 240, v4
    s_add_u32 m0, s66, 15360
    s_add_u32 s58, s67, 15360
    buffer_load_dwordx4 v11, s[12:15], s58 offen lds
    s_waitcnt vmcnt(15)
    v_xor_b32 v11, 112, v4
    s_add_u32 m0, s66, 27648
    s_add_u32 s58, s67, 27648
    buffer_load_dwordx4 v11, s[12:15], s58 offen lds
    s_waitcnt vmcnt(15)
    v_xor_b32 v11, 0, v4
    s_add_u32 m0, s66, 16384
    s_add_u32 s58, s67, 16384
    buffer_load_dwordx4 v11, s[12:15], s58 offen lds
    s_waitcnt vmcnt(15)
    v_xor_b32 v11, 80, v4
    s_add_u32 m0, s66, 26624
    s_add_u32 s58, s67, 26624
    buffer_load_dwordx4 v11, s[12:15], s58 offen lds
    s_waitcnt vmcnt(15)
    v_xor_b32 v11, 32, v4
    s_add_u32 m0, s66, 17408
    s_add_u32 s58, s67, 17408
    buffer_load_dwordx4 v11, s[12:15], s58 offen lds
    s_waitcnt vmcnt(15)
    v_xor_b32 v11, 48, v4
    s_add_u32 m0, s66, 25600
    s_add_u32 s58, s67, 25600
    buffer_load_dwordx4 v11, s[12:15], s58 offen lds
    s_waitcnt vmcnt(15)
    v_xor_b32 v11, 64, v4
    s_add_u32 m0, s66, 18432
    s_add_u32 s58, s67, 18432
    buffer_load_dwordx4 v11, s[12:15], s58 offen lds
    s_waitcnt vmcnt(15)
    v_xor_b32 v11, 16, v4
    s_add_u32 m0, s66, 24576
    s_add_u32 s58, s67, 24576
    buffer_load_dwordx4 v11, s[12:15], s58 offen lds
    s_waitcnt vmcnt(15)
    v_xor_b32 v11, 96, v4
    s_add_u32 m0, s66, 19456
    s_add_u32 s58, s67, 19456
    buffer_load_dwordx4 v11, s[12:15], s58 offen lds
    s_waitcnt vmcnt(15)
    v_xor_b32 v11, 224, v4
    s_add_u32 m0, s66, 23552
    s_add_u32 s58, s67, 23552
    buffer_load_dwordx4 v11, s[12:15], s58 offen lds
    s_waitcnt vmcnt(15)
    v_xor_b32 v11, 128, v4
    s_add_u32 m0, s66, 20480
    s_add_u32 s58, s67, 20480
    buffer_load_dwordx4 v11, s[12:15], s58 offen lds
    s_waitcnt vmcnt(15)
    v_xor_b32 v11, 192, v4
    s_add_u32 m0, s66, 22528
    s_add_u32 s58, s67, 22528
    buffer_load_dwordx4 v11, s[12:15], s58 offen lds
    s_waitcnt vmcnt(15)
    v_xor_b32 v11, 160, v4
    s_add_u32 m0, s66, 21504
    s_add_u32 s58, s67, 21504
    buffer_load_dwordx4 v11, s[12:15], s58 offen lds
    s_waitcnt vmcnt(1)
    s_add_u32 m0, s64, 0
    s_add_u32 s58, s62, 0
    buffer_load_dwordx4 v16, s[44:47], s58 offen sc1 lds
    s_add_u32 m0, s64, 1024
    s_add_u32 s58, s62, 1024
    buffer_load_dwordx4 v17, s[44:47], s58 offen sc1 lds
    s_add_u32 m0, s64, 2048
    s_add_u32 s58, s62, 2048
    buffer_load_dwordx4 v18, s[44:47], s58 offen sc1 lds
    s_add_u32 m0, s64, 3072
    s_add_u32 s58, s62, 3072
    buffer_load_dwordx4 v19, s[44:47], s58 offen sc1 lds
    buffer_load_dword v24, v20, s[44:47], s63 offen sc1
    s_barrier
    v_xor_b32 v10, 0, v21
    ds_read_b128 v[128:131], v10
    v_xor_b32 v10, 16, v21
    ds_read_b128 v[132:135], v10
    v_xor_b32 v10, 32, v21
    ds_read_b128 v[136:139], v10
    v_xor_b32 v10, 48, v21
    ds_read_b128 v[140:143], v10
    v_xor_b32 v10, 64, v21
    ds_read_b128 v[144:147], v10
    v_xor_b32 v10, 80, v21
    ds_read_b128 v[148:151], v10
    v_xor_b32 v10, 96, v21
    ds_read_b128 v[152:155], v10
    v_xor_b32 v10, 112, v21
    ds_read_b128 v[156:159], v10
    v_xor_b32 v10, 128, v21
    ds_read_b128 v[160:163], v10
    v_xor_b32 v10, 144, v21
    ds_read_b128 v[164:167], v10
    v_xor_b32 v10, 160, v21
    ds_read_b128 v[168:171], v10
    v_xor_b32 v10, 176, v21
    ds_read_b128 v[172:175], v10
    v_xor_b32 v10, 192, v21
    ds_read_b128 v[176:179], v10
    v_xor_b32 v10, 208, v21
    ds_read_b128 v[180:183], v10
    v_xor_b32 v10, 224, v21
    ds_read_b128 v[184:187], v10
    v_xor_b32 v10, 240, v21
    ds_read_b128 v[188:191], v10
    s_branch L_att
L_F:
    s_mov_b32 s6, s66
    s_lshl_b32 s68, s68, 3
    s_add_u32 s68, s68, s52
    s_lshr_b32 s58, s2, 4
    s_lshl_b32 s56, s52, 4
    s_add_u32 s56, s56, s58
    s_mul_i32 s58, s52, 3
    s_max_u32 s59, s52, 6
    s_sub_u32 s58, s58, s59
    s_add_u32 s58, s58, 6
    s_lshr_b32 s59, s68, 3
    s_add_u32 s58, s58, s59
    s_lshl_b32 s59, s58, 1
    s_cmp_ge_u32 s58, 11
    s_cselect_b32 s58, 21, 0
    s_sub_u32 s59, s59, s58
    s_cmp_lt_u32 s68, 22
    s_cselect_b32 s68, s59, s68
    s_lshl_b32 s66, s3, 15
    s_lshl_b32 s67, s56, 17
    s_add_u32 s67, s67, s66
    s_mov_b32 s85, 0
    v_mov_b32 v14, 155648
    v_mov_b32 v15, 0
    ds_write_b32 v14, v15
    v_xor_b32 v16, v2, v3
    v_lshlrev_b32 v16, 4, v16
    v_lshl_add_u32 v16, v2, 9, v16
    v_add_u32 v16, s6, v16
    v_xor_b32 v17, 64, v16
    v_xor_b32 v18, 128, v16
    v_xor_b32 v19, 192, v16
    s_and_b32 s70, s3, 1
    s_lshl_b32 s70, s70, 13
    s_add_u32 s70, s70, 131072
    v_and_b32 v24, 7, v1
    v_lshlrev_b32 v25, 1, v24
    v_xor_b32 v25, v25, v3
    v_lshlrev_b32 v25, 4, v25
    v_lshl_add_u32 v24, v24, 10, v25
    v_bfe_u32 v25, v1, 3, 1
    v_lshl_add_u32 v24, v25, 9, v24
    v_add_u32 v24, s70, v24
    v_xor_b32 v25, 64, v24
    v_xor_b32 v26, 128, v24
    v_xor_b32 v27, 192, v24
    v_xor_b32 v176, 0, v4
    v_xor_b32 v177, 32, v4
    v_xor_b32 v178, 64, v4
    v_xor_b32 v179, 96, v4
    v_xor_b32 v180, 128, v4
    v_xor_b32 v181, 160, v4
    v_xor_b32 v182, 192, v4
    v_xor_b32 v183, 224, v4
    v_and_b32 v30, 31, v1
    v_lshlrev_b32 v30, 2, v30
    v_lshrrev_b32 v11, 5, v1
    v_lshl_add_u32 v30, v11, 15, v30
    v_lshlrev_b32 v31, 2, v1
    s_waitcnt lgkmcnt(0)
    s_add_u32 s7, s4, 1
    s_lshl_b32 s4, s7, 2
    s_and_b32 s4, s4, 0x3fff0000
    s_and_b32 s58, s7, 0x3fff
    s_or_b32 s4, s4, s58
    v_and_b32 v10, 1, v1
    v_cmp_ne_u32 s[72:73], 0, v10
    v_and_b32 v10, 2, v1
    v_cmp_ne_u32 s[74:75], 0, v10
    v_cmp_gt_u32 s[76:77], 4, v2
    s_lshl_b32 s5, s54, 13
    s_add_u32 s64, s5, 1376256
    s_add_u32 s5, s5, 65536
    s_lshl_b32 s58, s54, 3
    s_add_u32 s58, s58, s65
    s_lshl_b32 s6, s58, 8
    s_add_u32 s6, s6, 393216
    s_lshl_b32 s69, s58, 7
    s_add_u32 s69, s69, 327680
    v_lshrrev_b32 v31, 5, v1
    v_lshlrev_b32 v31, 11, v31
    v_and_b32 v10, 1, v3
    v_lshl_add_u32 v31, v10, 2, v31
    v_cmp_eq_u32 s[74:75], 0, v2
    s_lshr_b32 s6, s54, 4
    s_lshl_b32 s6, s6, 10
    s_and_b32 s58, s65, 1
    s_lshl_b32 s58, s58, 9
    s_add_u32 s6, s6, s58
    s_lshl_b32 s58, s55, 7
    s_add_u32 s6, s6, s58
    s_and_b32 s58, s54, 15
    s_lshl_b32 s58, s58, 3
    s_add_u32 s6, s6, s58
    s_add_u32 s6, s6, 393216
    s_cmp_ge_u32 s3, 2
    s_cbranch_scc1 L_wmF
    v_mov_b32 v56, -1
    v_mov_b32 v57, 0x80000000
    buffer_store_dword v56, v30, s[44:47], s69 offen sc1
    s_waitcnt vmcnt(1)
    s_branch L_wmG
L_wmF:
    s_waitcnt vmcnt(0)
L_wmG:
    s_barrier
    s_cmp_ge_u32 s3, 2
    s_cbranch_scc1 L_Bd
    ds_read_b128 v[64:67], v16 offset:0
    ds_read_b128 v[68:71], v17 offset:0
    ds_read_b128 v[72:75], v18 offset:0
    ds_read_b128 v[76:79], v19 offset:0
    ds_read_b128 v[80:83], v16 offset:8192
    ds_read_b128 v[84:87], v17 offset:8192
    ds_read_b128 v[88:91], v18 offset:8192
    ds_read_b128 v[92:95], v19 offset:8192
    ds_read_b128 v[96:99], v16 offset:256
    ds_read_b128 v[100:103], v17 offset:256
    ds_read_b128 v[104:107], v18 offset:256
    ds_read_b128 v[108:111], v19 offset:256
    ds_read_b128 v[112:115], v16 offset:8448
    ds_read_b128 v[116:119], v17 offset:8448
    ds_read_b128 v[120:123], v18 offset:8448
    ds_read_b128 v[124:127], v19 offset:8448
    s_mov_b32 s59, 0
    s_mov_b32 s62, s64
L_h1:
    s_mov_b32 m0, s70
    s_add_u32 s58, s62, 0
    buffer_load_dwordx4 v176, s[44:47], s58 offen sc1 lds
    s_add_u32 m0, m0, 1024
    s_add_u32 s58, s62, 1024
    buffer_load_dwordx4 v177, s[44:47], s58 offen sc1 lds
    s_add_u32 m0, m0, 1024
    s_add_u32 s58, s62, 2048
    buffer_load_dwordx4 v178, s[44:47], s58 offen sc1 lds
    s_add_u32 m0, m0, 1024
    s_add_u32 s58, s62, 3072
    buffer_load_dwordx4 v179, s[44:47], s58 offen sc1 lds
    s_add_u32 m0, m0, 1024
    s_add_u32 s58, s62, 4096
    buffer_load_dwordx4 v180, s[44:47], s58 offen sc1 lds
    s_add_u32 m0, m0, 1024
    s_add_u32 s58, s62, 5120
    buffer_load_dwordx4 v181, s[44:47], s58 offen sc1 lds
    s_add_u32 m0, m0, 1024
    s_add_u32 s58, s62, 6144
    buffer_load_dwordx4 v182, s[44:47], s58 offen sc1 lds
    s_add_u32 m0, m0, 1024
    s_add_u32 s58, s62, 7168
    buffer_load_dwordx4 v183, s[44:47], s58 offen sc1 lds
    s_waitcnt vmcnt(0)
    ds_read_b128 v[128:131], v24
    ds_read_b128 v[132:135], v24 offset:256
    ds_read_b128 v[136:139], v25
    ds_read_b128 v[140:143], v25 offset:256
    ds_read_b128 v[144:147], v26
    ds_read_b128 v[148:151], v26 offset:256
    ds_read_b128 v[152:155], v27
    ds_read_b128 v[156:159], v27 offset:256
    s_add_u32 s59, s59, 1
    s_waitcnt lgkmcnt(6)
    v_xor_b32 v10, s4, v129
    v_xor_b32 v11, s4, v134
    s_waitcnt lgkmcnt(4)
    v_xor_b32 v12, s4, v137
    v_xor_b32 v13, s4, v142
    v_or3_b32 v10, v10, v12, v13
    s_waitcnt lgkmcnt(2)
    v_xor_b32 v12, s4, v145
    v_xor_b32 v13, s4, v150
    v_or3_b32 v10, v10, v12, v13
    s_waitcnt lgkmcnt(0)
    v_xor_b32 v12, s4, v153
    v_xor_b32 v13, s4, v158
    v_or3_b32 v10, v10, v12, v13
    v_or_b32 v10, v10, v11
    v_cmp_ne_u32 vcc, 0, v10
    s_cmp_eq_u64 vcc, 0
    s_cbranch_scc1 L_h1_ok
    s_cmp_lt_u32 s59, 60000
    s_cbranch_scc1 L_h1
L_h1_ok:
    v_mfma_f32_16x16x32_bf16 v[160:163], v[130:133], v[64:67], 0
    v_mfma_f32_16x16x32_bf16 v[164:167], v[130:133], v[80:83], 0
    v_mfma_f32_16x16x32_bf16 v[168:171], v[130:133], v[96:99], 0
    v_mfma_f32_16x16x32_bf16 v[172:175], v[130:133], v[112:115], 0
    v_mfma_f32_16x16x32_bf16 v[160:163], v[138:141], v[68:71], v[160:163]
    v_mfma_f32_16x16x32_bf16 v[164:167], v[138:141], v[84:87], v[164:167]
    v_mfma_f32_16x16x32_bf16 v[168:171], v[138:141], v[100:103], v[168:171]
    v_mfma_f32_16x16x32_bf16 v[172:175], v[138:141], v[116:119], v[172:175]
    v_mfma_f32_16x16x32_bf16 v[160:163], v[146:149], v[72:75], v[160:163]
    v_mfma_f32_16x16x32_bf16 v[164:167], v[146:149], v[88:91], v[164:167]
    v_mfma_f32_16x16x32_bf16 v[168:171], v[146:149], v[104:107], v[168:171]
    v_mfma_f32_16x16x32_bf16 v[172:175], v[146:149], v[120:123], v[172:175]
    v_mfma_f32_16x16x32_bf16 v[160:163], v[154:157], v[76:79], v[160:163]
    v_mfma_f32_16x16x32_bf16 v[164:167], v[154:157], v[92:95], v[164:167]
    v_mfma_f32_16x16x32_bf16 v[168:171], v[154:157], v[108:111], v[168:171]
    v_mfma_f32_16x16x32_bf16 v[172:175], v[154:157], v[124:127], v[172:175]
    s_nop 4
    v_add_f32 v160, v160, v161
    v_add_f32 v162, v162, v163
    v_add_f32 v164, v164, v165
    v_add_f32 v166, v166, v167
    v_add_f32 v168, v168, v169
    v_add_f32 v170, v170, v171
    v_add_f32 v172, v172, v173
    v_add_f32 v174, v174, v175
    v_add_f32 v160, v160, v162
    v_add_f32 v164, v164, v166
    v_add_f32 v168, v168, v170
    v_add_f32 v172, v172, v174
    v_permlane16_swap_b32 v160, v164
    s_nop 0
    v_permlane16_swap_b32 v168, v172
    v_add_f32 v160, v160, v164
    v_add_f32 v168, v168, v172
    v_mul_f32 v160, 0x3e0293ee, v160
    v_mul_f32 v168, 0x3e0293ee, v168
    v_cvt_pk_bf16_f32 v32, v160, v168
    buffer_store_dword v32, v30, s[44:47], s69 offen sc1
    s_nop 0
    v_add_u32_dpp v33, v32, v32 row_ror:8 row_mask:0xf bank_mask:0xf
    s_nop 1
    v_add_u32_dpp v33, v33, v33 row_ror:4 row_mask:0xf bank_mask:0xf
    s_nop 1
    v_add_u32_dpp v33, v33, v33 row_ror:2 row_mask:0xf bank_mask:0xf
    s_nop 1
    v_add_u32_dpp v33, v33, v33 row_ror:1 row_mask:0xf bank_mask:0xf
    v_add_u32 v33, s4, v33
    s_mov_b64 exec, s[74:75]
    buffer_store_dword v33, v31, s[44:47], s6 offen sc1
    s_mov_b64 exec, -1
L_Bd:
    s_barrier
    v_xor_b32 v11, 240, v4
    s_add_u32 m0, s66, 31744
    s_add_u32 s58, s67, 31744
    buffer_load_dwordx4 v11, s[12:15], s58 offen lds
    v_xor_b32 v11, 0, v4
    s_add_u32 m0, s66, 0
    s_add_u32 s58, s67, 0
    buffer_load_dwordx4 v11, s[12:15], s58 offen lds
    v_xor_b32 v11, 208, v4
    s_add_u32 m0, s66, 30720
    s_add_u32 s58, s67, 30720
    buffer_load_dwordx4 v11, s[12:15], s58 offen lds
    v_xor_b32 v11, 32, v4
    s_add_u32 m0, s66, 1024
    s_add_u32 s58, s67, 1024
    buffer_load_dwordx4 v11, s[12:15], s58 offen lds
    v_xor_b32 v11, 176, v4
    s_add_u32 m0, s66, 29696
    s_add_u32 s58, s67, 29696
    buffer_load_dwordx4 v11, s[12:15], s58 offen lds
    v_xor_b32 v11, 64, v4
    s_add_u32 m0, s66, 2048
    s_add_u32 s58, s67, 2048
    buffer_load_dwordx4 v11, s[12:15], s58 offen lds
    v_xor_b32 v11, 144, v4
    s_add_u32 m0, s66, 28672
    s_add_u32 s58, s67, 28672
    buffer_load_dwordx4 v11, s[12:15], s58 offen lds
    v_xor_b32 v11, 96, v4
    s_add_u32 m0, s66, 3072
    s_add_u32 s58, s67, 3072
    buffer_load_dwordx4 v11, s[12:15], s58 offen lds
    v_xor_b32 v11, 112, v4
    s_add_u32 m0, s66, 27648
    s_add_u32 s58, s67, 27648
    buffer_load_dwordx4 v11, s[12:15], s58 offen lds
    v_xor_b32 v11, 128, v4
    s_add_u32 m0, s66, 4096
    s_add_u32 s58, s67, 4096
    buffer_load_dwordx4 v11, s[12:15], s58 offen lds
    v_xor_b32 v11, 80, v4
    s_add_u32 m0, s66, 26624
    s_add_u32 s58, s67, 26624
    buffer_load_dwordx4 v11, s[12:15], s58 offen lds
    v_xor_b32 v11, 160, v4
    s_add_u32 m0, s66, 5120
    s_add_u32 s58, s67, 5120
    buffer_load_dwordx4 v11, s[12:15], s58 offen lds
    v_xor_b32 v11, 48, v4
    s_add_u32 m0, s66, 25600
    s_add_u32 s58, s67, 25600
    buffer_load_dwordx4 v11, s[12:15], s58 offen lds
    v_xor_b32 v11, 192, v4
    s_add_u32 m0, s66, 6144
    s_add_u32 s58, s67, 6144
    buffer_load_dwordx4 v11, s[12:15], s58 offen lds
    v_xor_b32 v11, 16, v4
    s_add_u32 m0, s66, 24576
    s_add_u32 s58, s67, 24576
    buffer_load_dwordx4 v11, s[12:15], s58 offen lds
    v_xor_b32 v11, 224, v4
    s_add_u32 m0, s66, 7168
    s_add_u32 s58, s67, 7168
    buffer_load_dwordx4 v11, s[12:15], s58 offen lds
    s_lshr_b32 s58, s56, 6
    s_lshl_b32 s62, s58, 15
    s_lshl_b32 s63, s57, 14
    s_add_u32 s62, s62, s63
    s_lshl_b32 s64, s3, 12
    s_add_u32 s62, s62, s64
    s_add_u32 s62, s62, 327680
    s_add_u32 s64, s64, 131072
    s_lshl_b32 s63, s57, 15
    s_lshl_b32 s58, s58, 7
    s_add_u32 s63, s63, s58
    s_and_b32 s58, s3, 1
    s_lshl_b32 s58, s58, 8
    s_add_u32 s63, s63, s58
    s_add_u32 s63, s63, 393216
    s_lshl_b32 s58, s58, 2
    s_add_u32 s70, s58, 147456
    s_lshr_b32 s63, s56, 6
    s_lshl_b32 s63, s63, 11
    s_lshl_b32 s58, s57, 10
    s_add_u32 s63, s63, s58
    s_lshr_b32 s58, s3, 1
    s_lshl_b32 s58, s58, 9
    s_add_u32 s63, s63, s58
    s_and_b32 s58, s3, 1
    s_lshl_b32 s58, s58, 2
    s_add_u32 s63, s63, s58
    s_add_u32 s63, s63, 393216
    v_lshlrev_b32 v20, 3, v1
    s_and_b32 s58, s3, 1
    s_lshl_b32 s58, s58, 7
    s_lshr_b32 s59, s3, 1
    s_lshl_b32 s59, s59, 4
    s_or_b32 s58, s58, s59
    v_xor_b32 v16, s58, v4
    v_xor_b32 v17, 32, v16
    v_xor_b32 v18, 64, v16
    v_xor_b32 v19, 96, v16
    s_cmp_ge_u32 s3, 2
    s_cselect_b32 s86, 0, -1
    s_cselect_b32 s87, -1, 0
    v_and_b32 v10, 7, v2
    v_lshlrev_b32 v10, 1, v10
    v_lshrrev_b32 v11, 3, v2
    v_or_b32 v10, v10, v11
    v_lshlrev_b32 v10, 4, v10
    v_lshl_add_u32 v10, v3, 8, v10
    v_lshl_add_u32 v10, v2, 10, v10
    v_add_u32 v21, s66, v10
    v_add_u32 v22, 131072, v10
    v_lshl_add_u32 v21, v11, 14, v21
    s_lshl_b32 s58, s3, 6
    v_xor_b32 v21, s58, v21
    v_xor_b32 v22, s58, v22
    v_xor_b32 v23, 0x4000, v21
    v_xor_b32 v240, 0, v22
    v_xor_b32 v224, 0, v23
    v_xor_b32 v241, 16, v22
    v_xor_b32 v225, 16, v23
    v_xor_b32 v242, 32, v22
    v_xor_b32 v226, 32, v23
    v_xor_b32 v243, 48, v22
    v_xor_b32 v227, 48, v23
    v_xor_b32 v244, 64, v22
    v_xor_b32 v228, 64, v23
    v_xor_b32 v245, 80, v22
    v_xor_b32 v229, 80, v23
    v_xor_b32 v246, 96, v22
    v_xor_b32 v230, 96, v23
    v_xor_b32 v247, 112, v22
    v_xor_b32 v231, 112, v23
    v_xor_b32 v248, 128, v22
    v_xor_b32 v232, 128, v23
    v_xor_b32 v249, 144, v22
    v_xor_b32 v233, 144, v23
    v_xor_b32 v250, 160, v22
    v_xor_b32 v234, 160, v23
    v_xor_b32 v251, 176, v22
    v_xor_b32 v235, 176, v23
    v_xor_b32 v252, 192, v22
    v_xor_b32 v236, 192, v23
    v_xor_b32 v253, 208, v22
    v_xor_b32 v237, 208, v23
    v_xor_b32 v254, 224, v22
    v_xor_b32 v238, 224, v23
    v_xor_b32 v255, 240, v22
    v_xor_b32 v239, 240, v23
    v_lshrrev_b32 v10, 2, v2
    v_lshl_add_u32 v10, v3, 2, v10
    v_and_b32 v11, 7, v10
    v_lshlrev_b32 v11, 1, v11
    v_lshrrev_b32 v12, 3, v10
    v_or_b32 v11, v11, v12
    v_bfe_u32 v12, v2, 1, 1
    v_xor_b32 v11, v11, v12
    v_lshlrev_b32 v11, 4, v11
    v_and_b32 v12, 1, v2
    v_lshl_add_u32 v11, v12, 3, v11
    v_lshl_add_u32 v23, v10, 10, v11
    s_lshl_b32 s58, s3, 8
    v_add_u32 v23, s58, v23
    v_lshrrev_b32 v12, 1, v3
    v_lshl_add_u32 v23, v12, 14, v23
    v_xor_b32 v192, 0, v23
    v_xor_b32 v200, 16384, v23
    v_xor_b32 v193, 32, v23
    v_xor_b32 v201, 16416, v23
    v_xor_b32 v194, 64, v23
    v_xor_b32 v202, 16448, v23
    v_xor_b32 v195, 96, v23
    v_xor_b32 v203, 16480, v23
    v_xor_b32 v196, 128, v23
    v_xor_b32 v204, 16512, v23
    v_xor_b32 v197, 160, v23
    v_xor_b32 v205, 16544, v23
    v_xor_b32 v198, 192, v23
    v_xor_b32 v206, 16576, v23
    v_xor_b32 v199, 224, v23
    v_xor_b32 v207, 16608, v23
    v_add_u32 v208, 0x10000, v192
    v_add_u32 v209, 0x10000, v193
    v_add_u32 v210, 0x10000, v194
    v_add_u32 v211, 0x10000, v195
    v_add_u32 v212, 0x10000, v196
    v_add_u32 v213, 0x10000, v197
    v_add_u32 v214, 0x10000, v198
    v_add_u32 v215, 0x10000, v199
    v_add_u32 v216, 0x10000, v200
    v_add_u32 v217, 0x10000, v201
    v_add_u32 v218, 0x10000, v202
    v_add_u32 v219, 0x10000, v203
    v_add_u32 v220, 0x10000, v204
    v_add_u32 v221, 0x10000, v205
    v_add_u32 v222, 0x10000, v206
    v_add_u32 v223, 0x10000, v207
    v_lshlrev_b32 v42, 2, v2
    s_lshl_b32 s58, s3, 6
    v_add_u32 v42, 149504, v42
    v_add_u32 v43, s58, v42
    s_lshl_b32 s58, s3, 10
    v_add_u32 v44, 150016, v4
    v_add_u32 v45, s58, v44
    v_and_b32 v10, 3, v2
    v_lshl_add_u32 v46, v3, 2, v10
    v_lshlrev_b32 v47, 4, v46
    v_lshlrev_b32 v46, 2, v46
    v_add_u32 v46, 149504, v46
    v_lshlrev_b32 v48, 4, v2
    v_lshl_add_u32 v48, v3, 19, v48
    v_and_b32 v10, 1, v1
    v_cmp_ne_u32 s[72:73], 0, v10
    v_and_b32 v10, 2, v1
    v_cmp_ne_u32 s[74:75], 0, v10
    v_cmp_gt_u32 s[76:77], 4, v2
    v_mov_b32 v52, 0x3f803f80
    v_mov_b32 v53, v52
    v_mov_b32 v54, v52
    v_mov_b32 v55, v52
    v_mov_b32 v63, s4
    s_lshl_b32 s78, s56, 8
    s_lshl_b32 s58, s57, 21
    s_add_u32 s78, s78, s58
    s_add_u32 s78, s78, s66
    s_lshl_b32 s59, s3, 8
    s_add_u32 s78, s78, 2097152
    s_add_u32 s80, s78, 131072
    s_add_u32 s81, s78, 262144
    s_add_u32 s82, s78, 393216
    s_lshl_b32 s58, s56, 8
    s_sub_u32 s78, s78, s58
    s_sub_u32 s80, s80, s58
    s_sub_u32 s81, s81, s58
    s_sub_u32 s82, s82, s58
    s_lshl_b32 s58, s57, 6
    s_add_u32 s58, s58, s3
    s_mul_i32 s58, s58, 17
    s_add_u32 s58, s58, s56
    v_mul_u32_u24 v10, 272, v3
    v_add_u32 v10, s58, v10
    v_add_u32 v11, 0, v10
    v_and_b32 v11, 127, v11
    v_lshl_add_u32 v28, v11, 8, v48
    v_add_u32 v11, 68, v10
    v_and_b32 v11, 127, v11
    v_lshl_add_u32 v29, v11, 8, v48
    v_add_u32 v11, 136, v10
    v_and_b32 v11, 127, v11
    v_lshl_add_u32 v30, v11, 8, v48
    v_add_u32 v11, 204, v10
    v_and_b32 v11, 127, v11
    v_lshl_add_u32 v31, v11, 8, v48
    v_lshlrev_b32 v47, 9, v47
    s_andn2_b32 s79, s56, 31
    s_and_b32 s58, s56, 3
    s_lshl_b32 s58, s58, 3
    s_or_b32 s79, s79, s58
    s_bfe_u32 s58, s56, 0x30002
    s_or_b32 s79, s79, s58
    s_lshl_b32 s79, s79, 4
    s_lshl_b32 s58, s57, 17
    s_add_u32 s79, s79, s58
    s_lshl_b32 s58, s3, 11
    s_add_u32 s79, s79, s58
    s_add_u32 s79, s79, 7340032
    s_lshr_b32 s58, s3, 1
    s_lshl_b32 s58, s58, 10
    s_and_b32 s59, s3, 1
    s_lshl_b32 s59, s59, 2
    s_add_u32 s58, s58, s59
    s_add_u32 s58, s58, 147456
    v_add_u32 v49, s58, v4
    v_mov_b32 v50, 0x7f800000
    s_waitcnt vmcnt(15)
    v_xor_b32 v11, 224, v4
    s_add_u32 m0, s66, 23552
    s_add_u32 s58, s67, 23552
    buffer_load_dwordx4 v11, s[12:15], s58 offen lds
    s_waitcnt vmcnt(15)
    v_xor_b32 v11, 16, v4
    s_add_u32 m0, s66, 8192
    s_add_u32 s58, s67, 8192
    buffer_load_dwordx4 v11, s[12:15], s58 offen lds
    s_waitcnt vmcnt(15)
    v_xor_b32 v11, 192, v4
    s_add_u32 m0, s66, 22528
    s_add_u32 s58, s67, 22528
    buffer_load_dwordx4 v11, s[12:15], s58 offen lds
    s_waitcnt vmcnt(15)
    v_xor_b32 v11, 48, v4
    s_add_u32 m0, s66, 9216
    s_add_u32 s58, s67, 9216
    buffer_load_dwordx4 v11, s[12:15], s58 offen lds
    s_waitcnt vmcnt(15)
    v_xor_b32 v11, 160, v4
    s_add_u32 m0, s66, 21504
    s_add_u32 s58, s67, 21504
    buffer_load_dwordx4 v11, s[12:15], s58 offen lds
    s_waitcnt vmcnt(15)
    v_xor_b32 v11, 80, v4
    s_add_u32 m0, s66, 10240
    s_add_u32 s58, s67, 10240
    buffer_load_dwordx4 v11, s[12:15], s58 offen lds
    s_waitcnt vmcnt(15)
    v_xor_b32 v11, 128, v4
    s_add_u32 m0, s66, 20480
    s_add_u32 s58, s67, 20480
    buffer_load_dwordx4 v11, s[12:15], s58 offen lds
    s_waitcnt vmcnt(15)
    v_xor_b32 v11, 112, v4
    s_add_u32 m0, s66, 11264
    s_add_u32 s58, s67, 11264
    buffer_load_dwordx4 v11, s[12:15], s58 offen lds
    s_waitcnt vmcnt(15)
    v_xor_b32 v11, 96, v4
    s_add_u32 m0, s66, 19456
    s_add_u32 s58, s67, 19456
    buffer_load_dwordx4 v11, s[12:15], s58 offen lds
    s_waitcnt vmcnt(15)
    v_xor_b32 v11, 144, v4
    s_add_u32 m0, s66, 12288
    s_add_u32 s58, s67, 12288
    buffer_load_dwordx4 v11, s[12:15], s58 offen lds
    s_waitcnt vmcnt(15)
    v_xor_b32 v11, 64, v4
    s_add_u32 m0, s66, 18432
    s_add_u32 s58, s67, 18432
    buffer_load_dwordx4 v11, s[12:15], s58 offen lds
    s_waitcnt vmcnt(15)
    v_xor_b32 v11, 176, v4
    s_add_u32 m0, s66, 13312
    s_add_u32 s58, s67, 13312
    buffer_load_dwordx4 v11, s[12:15], s58 offen lds
    s_waitcnt vmcnt(15)
    v_xor_b32 v11, 32, v4
    s_add_u32 m0, s66, 17408
    s_add_u32 s58, s67, 17408
    buffer_load_dwordx4 v11, s[12:15], s58 offen lds
    s_waitcnt vmcnt(15)
    v_xor_b32 v11, 208, v4
    s_add_u32 m0, s66, 14336
    s_add_u32 s58, s67, 14336
    buffer_load_dwordx4 v11, s[12:15], s58 offen lds
    s_waitcnt vmcnt(15)
    v_xor_b32 v11, 0, v4
    s_add_u32 m0, s66, 16384
    s_add_u32 s58, s67, 16384
    buffer_load_dwordx4 v11, s[12:15], s58 offen lds
    s_waitcnt vmcnt(15)
    v_xor_b32 v11, 240, v4
    s_add_u32 m0, s66, 15360
    s_add_u32 s58, s67, 15360
    buffer_load_dwordx4 v11, s[12:15], s58 offen lds
    s_waitcnt vmcnt(6)
    s_add_u32 m0, s64, 0
    s_add_u32 s58, s62, 0
    buffer_load_dwordx4 v16, s[44:47], s58 offen sc1 lds
    s_add_u32 m0, s64, 1024
    s_add_u32 s58, s62, 1024
    buffer_load_dwordx4 v17, s[44:47], s58 offen sc1 lds
    s_add_u32 m0, s64, 2048
    s_add_u32 s58, s62, 2048
    buffer_load_dwordx4 v18, s[44:47], s58 offen sc1 lds
    s_add_u32 m0, s64, 3072
    s_add_u32 s58, s62, 3072
    buffer_load_dwordx4 v19, s[44:47], s58 offen sc1 lds
    buffer_load_dword v24, v20, s[44:47], s63 offen sc1
    s_barrier
    v_xor_b32 v10, 0, v21
    ds_read_b128 v[128:131], v10
    v_xor_b32 v10, 16, v21
    ds_read_b128 v[132:135], v10
    v_xor_b32 v10, 32, v21
    ds_read_b128 v[136:139], v10
    v_xor_b32 v10, 48, v21
    ds_read_b128 v[140:143], v10
    v_xor_b32 v10, 64, v21
    ds_read_b128 v[144:147], v10
    v_xor_b32 v10, 80, v21
    ds_read_b128 v[148:151], v10
    v_xor_b32 v10, 96, v21
    ds_read_b128 v[152:155], v10
    v_xor_b32 v10, 112, v21
    ds_read_b128 v[156:159], v10
    v_xor_b32 v10, 128, v21
    ds_read_b128 v[160:163], v10
    v_xor_b32 v10, 144, v21
    ds_read_b128 v[164:167], v10
    v_xor_b32 v10, 160, v21
    ds_read_b128 v[168:171], v10
    v_xor_b32 v10, 176, v21
    ds_read_b128 v[172:175], v10
    v_xor_b32 v10, 192, v21
    ds_read_b128 v[176:179], v10
    v_xor_b32 v10, 208, v21
    ds_read_b128 v[180:183], v10
    v_xor_b32 v10, 224, v21
    ds_read_b128 v[184:187], v10
    v_xor_b32 v10, 240, v21
    ds_read_b128 v[188:191], v10
L_att:
    s_waitcnt vmcnt(0) lgkmcnt(0)
    s_barrier
    s_mov_b32 s59, 0
L_qk:
    ds_read_b128 v[64:67], v240
    ds_read_b128 v[68:71], v241
    ds_read_b128 v[72:75], v242
    ds_read_b128 v[76:79], v243
    ds_read_b128 v[80:83], v244
    ds_read_b128 v[84:87], v245
    ds_read_b128 v[88:91], v246
    ds_read_b128 v[92:95], v247
    ds_read_b128 v[96:99], v248
    ds_read_b128 v[100:103], v249
    ds_read_b128 v[104:107], v250
    ds_read_b128 v[108:111], v251
    s_waitcnt lgkmcnt(10)
    v_mfma_f32_16x16x32_bf16 v[32:35], v[128:131], v[64:67], 0
    ds_read_b128 v[112:115], v252
    ds_read_b128 v[128:131], v224
    v_mfma_f32_16x16x32_bf16 v[32:35], v[132:135], v[68:71], v[32:35]
    ds_read_b128 v[116:119], v253
    ds_read_b128 v[132:135], v225
    s_waitcnt lgkmcnt(12)
    v_mfma_f32_16x16x32_bf16 v[32:35], v[136:139], v[72:75], v[32:35]
    ds_read_b128 v[120:123], v254
    ds_read_b128 v[136:139], v226
    v_mfma_f32_16x16x32_bf16 v[32:35], v[140:143], v[76:79], v[32:35]
    ds_read_b128 v[124:127], v255
    ds_read_b128 v[140:143], v227
    s_waitcnt lgkmcnt(14)
    v_mfma_f32_16x16x32_bf16 v[32:35], v[144:147], v[80:83], v[32:35]
    ds_read_b128 v[144:147], v228
    v_add3_u32 v26, v64, v65, s4
    v_mfma_f32_16x16x32_bf16 v[32:35], v[148:151], v[84:87], v[32:35]
    ds_read_b128 v[148:151], v229
    v_add3_u32 v27, v66, v67, v68
    s_waitcnt lgkmcnt(14)
    v_mfma_f32_16x16x32_bf16 v[32:35], v[152:155], v[88:91], v[32:35]
    ds_read_b128 v[152:155], v230
    v_add3_u32 v26, v69, v70, v26
    s_waitcnt lgkmcnt(7)
    v_mfma_f32_16x16x32_bf16 v[36:39], v[128:131], v[64:67], 0
    v_mfma_f32_16x16x32_bf16 v[32:35], v[156:159], v[92:95], v[32:35]
    ds_read_b128 v[156:159], v231
    v_add3_u32 v27, v71, v72, v27
    v_mfma_f32_16x16x32_bf16 v[36:39], v[132:135], v[68:71], v[36:39]
    s_waitcnt lgkmcnt(14)
    v_mfma_f32_16x16x32_bf16 v[32:35], v[160:163], v[96:99], v[32:35]
    ds_read_b128 v[160:163], v232
    v_add3_u32 v26, v73, v74, v26
    s_waitcnt lgkmcnt(5)
    v_mfma_f32_16x16x32_bf16 v[36:39], v[136:139], v[72:75], v[36:39]
    v_mfma_f32_16x16x32_bf16 v[32:35], v[164:167], v[100:103], v[32:35]
    ds_read_b128 v[164:167], v233
    v_add3_u32 v27, v75, v76, v27
    v_mfma_f32_16x16x32_bf16 v[36:39], v[140:143], v[76:79], v[36:39]
    s_waitcnt lgkmcnt(14)
    v_mfma_f32_16x16x32_bf16 v[32:35], v[168:171], v[104:107], v[32:35]
    ds_read_b128 v[168:171], v234
    v_add3_u32 v26, v77, v78, v26
    s_waitcnt lgkmcnt(5)
    v_mfma_f32_16x16x32_bf16 v[36:39], v[144:147], v[80:83], v[36:39]
    v_mfma_f32_16x16x32_bf16 v[32:35], v[172:175], v[108:111], v[32:35]
    ds_read_b128 v[172:175], v235
    v_add3_u32 v26, v26, v27, v79
    v_mfma_f32_16x16x32_bf16 v[36:39], v[148:151], v[84:87], v[36:39]
    s_waitcnt lgkmcnt(13)
    v_mfma_f32_16x16x32_bf16 v[32:35], v[176:179], v[112:115], v[32:35]
    ds_read_b128 v[176:179], v236
    s_waitcnt lgkmcnt(5)
    v_mfma_f32_16x16x32_bf16 v[36:39], v[152:155], v[88:91], v[36:39]
    v_mfma_f32_16x16x32_bf16 v[32:35], v[180:183], v[116:119], v[32:35]
    ds_read_b128 v[180:183], v237
    v_mfma_f32_16x16x32_bf16 v[36:39], v[156:159], v[92:95], v[36:39]
    s_waitcnt lgkmcnt(11)
    v_mfma_f32_16x16x32_bf16 v[32:35], v[184:187], v[120:123], v[32:35]
    ds_read_b128 v[184:187], v238
    s_waitcnt lgkmcnt(5)
    v_mfma_f32_16x16x32_bf16 v[36:39], v[160:163], v[96:99], v[36:39]
    v_mfma_f32_16x16x32_bf16 v[32:35], v[188:191], v[124:127], v[32:35]
    ds_read_b128 v[188:191], v239
    v_mfma_f32_16x16x32_bf16 v[36:39], v[164:167], v[100:103], v[36:39]
    s_waitcnt lgkmcnt(4)
    v_mfma_f32_16x16x32_bf16 v[36:39], v[168:171], v[104:107], v[36:39]
    v_mfma_f32_16x16x32_bf16 v[36:39], v[172:175], v[108:111], v[36:39]
    s_waitcnt lgkmcnt(2)
    v_mfma_f32_16x16x32_bf16 v[36:39], v[176:179], v[112:115], v[36:39]
    v_mfma_f32_16x16x32_bf16 v[36:39], v[180:183], v[116:119], v[36:39]
    s_waitcnt lgkmcnt(0)
    v_mfma_f32_16x16x32_bf16 v[36:39], v[184:187], v[120:123], v[36:39]
    v_mfma_f32_16x16x32_bf16 v[36:39], v[188:191], v[124:127], v[36:39]
    v_cmp_ne_u32 vcc, v26, v24
    v_max3_f32 v40, v32, v33, v34
    v_max_f32 v40, v40, v35
    v_cndmask_b32 v40, v40, v50, vcc
    ds_read_b64_tr_b16 v[128:129], v192 offset:0
    ds_read_b64_tr_b16 v[130:131], v200 offset:0
    ds_read_b64_tr_b16 v[132:133], v193 offset:0
    ds_read_b64_tr_b16 v[134:135], v201 offset:0
    v_max3_f32 v40, v40, v36, v37
    ds_read_b64_tr_b16 v[136:137], v194 offset:0
    ds_read_b64_tr_b16 v[138:139], v202 offset:0
    v_max3_f32 v40, v40, v38, v39
    ds_read_b64_tr_b16 v[140:141], v195 offset:0
    ds_read_b64_tr_b16 v[142:143], v203 offset:0
    v_mov_b32 v41, v40
    ds_read_b64_tr_b16 v[144:145], v196 offset:0
    ds_read_b64_tr_b16 v[146:147], v204 offset:0
    v_permlane16_swap_b32 v41, v40
    ds_read_b64_tr_b16 v[148:149], v197 offset:0
    ds_read_b64_tr_b16 v[150:151], v205 offset:0
    v_max_f32 v40, v41, v40
    ds_read_b64_tr_b16 v[152:153], v198 offset:0
    ds_read_b64_tr_b16 v[154:155], v206 offset:0
    v_mov_b32 v41, v40
    ds_read_b64_tr_b16 v[156:157], v199 offset:0
    ds_read_b64_tr_b16 v[158:159], v207 offset:0
    v_permlane32_swap_b32 v41, v40
    v_max_f32 v40, v41, v40
    v_ceil_f32 v40, v40
    ds_write_b32 v43, v40
    v_sub_f32 v32, v32, v40
    v_sub_f32 v33, v33, v40
    v_sub_f32 v34, v34, v40
    v_sub_f32 v35, v35, v40
    v_sub_f32 v36, v36, v40
    v_sub_f32 v37, v37, v40
    v_sub_f32 v38, v38, v40
    v_sub_f32 v39, v39, v40
    v_exp_f32 v32, v32
    v_exp_f32 v33, v33
    v_exp_f32 v34, v34
    v_exp_f32 v35, v35
    v_exp_f32 v36, v36
    v_exp_f32 v37, v37
    v_exp_f32 v38, v38
    v_exp_f32 v39, v39
    v_cvt_pk_bf16_f32 v56, v32, v33
    v_cvt_pk_bf16_f32 v57, v34, v35
    v_cvt_pk_bf16_f32 v58, v36, v37
    v_cvt_pk_bf16_f32 v59, v38, v39
    ds_write_b128 v45, v[56:59]
    s_waitcnt lgkmcnt(0)
    s_cmp_lg_u32 s59, 0
    s_cbranch_scc1 L_smspin
    s_barrier
L_smj:
    ds_read2_b32 v[32:33], v42 offset0:0 offset1:16
    ds_read2_b32 v[34:35], v42 offset0:32 offset1:48
    ds_read_b128 v[64:67], v44 offset:0
    ds_read_b128 v[68:71], v44 offset:1024
    ds_read_b128 v[72:75], v44 offset:2048
    ds_read_b128 v[76:79], v44 offset:3072
    ds_read_b64_tr_b16 v[160:161], v192 offset:32768
    ds_read_b64_tr_b16 v[162:163], v200 offset:32768
    ds_read_b64_tr_b16 v[164:165], v193 offset:32768
    ds_read_b64_tr_b16 v[166:167], v201 offset:32768
    ds_read_b64_tr_b16 v[168:169], v194 offset:32768
    ds_read_b64_tr_b16 v[170:171], v202 offset:32768
    ds_read_b64_tr_b16 v[172:173], v195 offset:32768
    ds_read_b64_tr_b16 v[174:175], v203 offset:32768
    s_waitcnt lgkmcnt(12)
    v_max3_f32 v40, v32, v33, v34
    v_max_f32 v40, v40, v35
    v_sub_f32 v32, v40, v32
    v_cvt_u32_f32 v32, v32
    v_min_u32 v32, 255, v32
    v_mul_u32_u24 v32, 0x800080, v32
    v_cmp_eq_f32 vcc, v40, v50
    s_waitcnt lgkmcnt(11)
    v_pk_sub_u16 v64, v64, v32 clamp
    v_pk_sub_u16 v65, v65, v32 clamp
    v_pk_sub_u16 v66, v66, v32 clamp
    v_pk_sub_u16 v67, v67, v32 clamp
    s_cbranch_vccnz L_qretry
L_go:
    s_nop 0
    v_mfma_f32_16x16x32_bf16 v[96:99], v[64:67], v[128:131], 0
    ds_read_b64_tr_b16 v[176:177], v196 offset:32768
    ds_read_b64_tr_b16 v[178:179], v204 offset:32768
    v_sub_f32 v33, v40, v33
    v_mfma_f32_16x16x32_bf16 v[100:103], v[64:67], v[132:135], 0
    ds_read_b64_tr_b16 v[180:181], v197 offset:32768
    ds_read_b64_tr_b16 v[182:183], v205 offset:32768
    v_cvt_u32_f32 v33, v33
    v_mfma_f32_16x16x32_bf16 v[104:107], v[64:67], v[136:139], 0
    ds_read_b64_tr_b16 v[184:185], v198 offset:32768
    ds_read_b64_tr_b16 v[186:187], v206 offset:32768
    v_min_u32 v33, 255, v33
    v_mfma_f32_16x16x32_bf16 v[108:111], v[64:67], v[140:143], 0
    ds_read_b64_tr_b16 v[188:189], v199 offset:32768
    ds_read_b64_tr_b16 v[190:191], v207 offset:32768
    v_mul_u32_u24 v33, 0x800080, v33
    v_mfma_f32_16x16x32_bf16 v[112:115], v[64:67], v[144:147], 0
    ds_read_b64_tr_b16 v[224:225], v208 offset:0
    ds_read_b64_tr_b16 v[226:227], v216 offset:0
    s_waitcnt lgkmcnt(15)
    v_mfma_f32_16x16x32_bf16 v[116:119], v[64:67], v[148:151], 0
    ds_read_b64_tr_b16 v[228:229], v209 offset:0
    ds_read_b64_tr_b16 v[230:231], v217 offset:0
    v_pk_sub_u16 v68, v68, v33 clamp
    v_mfma_f32_16x16x32_bf16 v[120:123], v[64:67], v[152:155], 0
    ds_read_b64_tr_b16 v[232:233], v210 offset:0
    ds_read_b64_tr_b16 v[234:235], v218 offset:0
    v_pk_sub_u16 v69, v69, v33 clamp
    v_mfma_f32_16x16x32_bf16 v[124:127], v[64:67], v[156:159], 0
    ds_read_b64_tr_b16 v[236:237], v211 offset:0
    ds_read_b64_tr_b16 v[238:239], v219 offset:0
    v_pk_sub_u16 v70, v70, v33 clamp
    v_pk_sub_u16 v71, v71, v33 clamp
    v_mfma_f32_16x16x32_bf16 v[80:83], v[64:67], v[52:55], 0
    s_waitcnt lgkmcnt(15)
    v_mfma_f32_16x16x32_bf16 v[96:99], v[68:71], v[160:163], v[96:99]
    ds_read_b64_tr_b16 v[240:241], v212 offset:0
    ds_read_b64_tr_b16 v[242:243], v220 offset:0
    v_sub_f32 v34, v40, v34
    v_mfma_f32_16x16x32_bf16 v[100:103], v[68:71], v[164:167], v[100:103]
    ds_read_b64_tr_b16 v[244:245], v213 offset:0
    ds_read_b64_tr_b16 v[246:247], v221 offset:0
    v_cvt_u32_f32 v34, v34
    s_waitcnt lgkmcnt(15)
    v_mfma_f32_16x16x32_bf16 v[104:107], v[68:71], v[168:171], v[104:107]
    ds_read_b64_tr_b16 v[248:249], v214 offset:0
    ds_read_b64_tr_b16 v[250:251], v222 offset:0
    v_min_u32 v34, 255, v34
    v_mfma_f32_16x16x32_bf16 v[108:111], v[68:71], v[172:175], v[108:111]
    ds_read_b64_tr_b16 v[252:253], v215 offset:0
    ds_read_b64_tr_b16 v[254:255], v223 offset:0
    v_mul_u32_u24 v34, 0x800080, v34
    s_waitcnt lgkmcnt(15)
    v_mfma_f32_16x16x32_bf16 v[112:115], v[68:71], v[176:179], v[112:115]
    ds_read_b64_tr_b16 v[128:129], v208 offset:32768
    ds_read_b64_tr_b16 v[130:131], v216 offset:32768
    v_pk_sub_u16 v72, v72, v34 clamp
    v_mfma_f32_16x16x32_bf16 v[116:119], v[68:71], v[180:183], v[116:119]
    ds_read_b64_tr_b16 v[132:133], v209 offset:32768
    ds_read_b64_tr_b16 v[134:135], v217 offset:32768
    v_pk_sub_u16 v73, v73, v34 clamp
    s_waitcnt lgkmcnt(15)
    v_mfma_f32_16x16x32_bf16 v[120:123], v[68:71], v[184:187], v[120:123]
    ds_read_b64_tr_b16 v[136:137], v210 offset:32768
    ds_read_b64_tr_b16 v[138:139], v218 offset:32768
    v_pk_sub_u16 v74, v74, v34 clamp
    v_mfma_f32_16x16x32_bf16 v[124:127], v[68:71], v[188:191], v[124:127]
    ds_read_b64_tr_b16 v[140:141], v211 offset:32768
    ds_read_b64_tr_b16 v[142:143], v219 offset:32768
    v_pk_sub_u16 v75, v75, v34 clamp
    v_mfma_f32_16x16x32_bf16 v[80:83], v[68:71], v[52:55], v[80:83]
    s_waitcnt lgkmcnt(15)
    v_mfma_f32_16x16x32_bf16 v[96:99], v[72:75], v[224:227], v[96:99]
    ds_read_b64_tr_b16 v[144:145], v212 offset:32768
    ds_read_b64_tr_b16 v[146:147], v220 offset:32768
    v_sub_f32 v35, v40, v35
    v_mfma_f32_16x16x32_bf16 v[100:103], v[72:75], v[228:231], v[100:103]
    ds_read_b64_tr_b16 v[148:149], v213 offset:32768
    ds_read_b64_tr_b16 v[150:151], v221 offset:32768
    v_cvt_u32_f32 v35, v35
    s_waitcnt lgkmcnt(15)
    v_mfma_f32_16x16x32_bf16 v[104:107], v[72:75], v[232:235], v[104:107]
    ds_read_b64_tr_b16 v[152:153], v214 offset:32768
    ds_read_b64_tr_b16 v[154:155], v222 offset:32768
    v_min_u32 v35, 255, v35
    v_mfma_f32_16x16x32_bf16 v[108:111], v[72:75], v[236:239], v[108:111]
    ds_read_b64_tr_b16 v[156:157], v215 offset:32768
    ds_read_b64_tr_b16 v[158:159], v223 offset:32768
    v_mul_u32_u24 v35, 0x800080, v35
    s_waitcnt lgkmcnt(15)
    v_mfma_f32_16x16x32_bf16 v[112:115], v[72:75], v[240:243], v[112:115]
    v_pk_sub_u16 v76, v76, v35 clamp
    v_mfma_f32_16x16x32_bf16 v[116:119], v[72:75], v[244:247], v[116:119]
    v_pk_sub_u16 v77, v77, v35 clamp
    s_waitcnt lgkmcnt(15)
    v_mfma_f32_16x16x32_bf16 v[120:123], v[72:75], v[248:251], v[120:123]
    v_pk_sub_u16 v78, v78, v35 clamp
    v_mfma_f32_16x16x32_bf16 v[124:127], v[72:75], v[252:255], v[124:127]
    v_pk_sub_u16 v79, v79, v35 clamp
    v_mfma_f32_16x16x32_bf16 v[80:83], v[72:75], v[52:55], v[80:83]
    s_waitcnt lgkmcnt(12)
    v_mfma_f32_16x16x32_bf16 v[96:99], v[76:79], v[128:131], v[96:99]
    v_mfma_f32_16x16x32_bf16 v[100:103], v[76:79], v[132:135], v[100:103]
    s_waitcnt lgkmcnt(8)
    v_mfma_f32_16x16x32_bf16 v[104:107], v[76:79], v[136:139], v[104:107]
    v_mfma_f32_16x16x32_bf16 v[108:111], v[76:79], v[140:143], v[108:111]
    s_waitcnt lgkmcnt(4)
    v_mfma_f32_16x16x32_bf16 v[112:115], v[76:79], v[144:147], v[112:115]
    v_mfma_f32_16x16x32_bf16 v[116:119], v[76:79], v[148:151], v[116:119]
    s_waitcnt lgkmcnt(0)
    v_mfma_f32_16x16x32_bf16 v[120:123], v[76:79], v[152:155], v[120:123]
    v_mfma_f32_16x16x32_bf16 v[124:127], v[76:79], v[156:159], v[124:127]
    v_mfma_f32_16x16x32_bf16 v[80:83], v[76:79], v[52:55], v[80:83]
    ds_read2_b32 v[36:37], v46 offset0:0 offset1:16
    ds_read2_b32 v[38:39], v46 offset0:32 offset1:48
    v_cvt_pk_bf16_f32 v128, v96, v100
    v_cvt_pk_bf16_f32 v129, v104, v108
    v_cvt_pk_bf16_f32 v130, v112, v116
    s_nop 1
    v_cvt_pk_bf16_f32 v131, v120, v124
    buffer_store_dwordx4 v[128:131], v28, s[44:47], s78 offen sc1
    v_add3_u32 v32, v128, v129, v130
    v_add_u32 v32, v32, v131
    v_cvt_pk_bf16_f32 v132, v97, v101
    v_cvt_pk_bf16_f32 v133, v105, v109
    v_cvt_pk_bf16_f32 v134, v113, v117
    v_cvt_pk_bf16_f32 v135, v121, v125
    buffer_store_dwordx4 v[132:135], v29, s[44:47], s80 offen sc1
    v_add3_u32 v33, v132, v133, v134
    v_add_u32 v33, v33, v135
    v_cvt_pk_bf16_f32 v136, v98, v102
    v_cvt_pk_bf16_f32 v137, v106, v110
    v_cvt_pk_bf16_f32 v138, v114, v118
    v_cvt_pk_bf16_f32 v139, v122, v126
    buffer_store_dwordx4 v[136:139], v30, s[44:47], s81 offen sc1
    v_add3_u32 v34, v136, v137, v138
    v_add_u32 v34, v34, v139
    v_cvt_pk_bf16_f32 v140, v99, v103
    v_cvt_pk_bf16_f32 v141, v107, v111
    v_cvt_pk_bf16_f32 v142, v115, v119
    v_cvt_pk_bf16_f32 v143, v123, v127
    buffer_store_dwordx4 v[140:143], v31, s[44:47], s82 offen sc1
    v_add3_u32 v35, v140, v141, v142
    v_add_u32 v35, v35, v143
    v_cndmask_b32 v40, v33, v32, s[72:73]
    v_cndmask_b32 v41, v35, v34, s[72:73]
    v_cndmask_b32 v32, v32, v33, s[72:73]
    v_cndmask_b32 v34, v34, v35, s[72:73]
    v_add_u32_dpp v32, v40, v32 quad_perm:[1,0,3,2] row_mask:0xf bank_mask:0xf
    v_add_u32_dpp v34, v41, v34 quad_perm:[1,0,3,2] row_mask:0xf bank_mask:0xf
    v_cndmask_b32 v80, v80, v81, s[72:73]
    v_cndmask_b32 v82, v82, v83, s[72:73]
    v_cndmask_b32 v40, v34, v32, s[74:75]
    v_cndmask_b32 v32, v32, v34, s[74:75]
    v_cndmask_b32 v61, v80, v82, s[74:75]
    s_waitcnt lgkmcnt(0)
    v_add_u32_dpp v32, v40, v32 quad_perm:[2,3,0,1] row_mask:0xf bank_mask:0xf
    v_max3_f32 v60, v36, v37, v38
    v_max_f32 v60, v60, v39
    v_add_u32_dpp v32, v32, v32 row_ror:4 row_mask:0xf bank_mask:0xf
    s_nop 1
    v_add_u32_dpp v32, v32, v32 row_ror:8 row_mask:0xf bank_mask:0xf
    v_add_u32 v62, s4, v32
    s_mov_b64 exec, s[76:77]
    buffer_store_dwordx4 v[60:63], v47, s[44:47], s79 offen sc1
    s_mov_b64 exec, -1
    s_barrier
    s_branch L_fin
L_smspin:
    s_add_u32 s85, s85, 4
    v_mov_b32 v14, 155648
    v_mov_b32 v15, 1
    s_mov_b64 exec, 1
    ds_add_u32 v14, v15
    s_mov_b64 exec, -1
    s_mov_b32 s84, 0
L_sbsm:
    ds_read_b32 v15, v14
    s_waitcnt lgkmcnt(0)
    v_readfirstlane_b32 s58, v15
    s_add_u32 s84, s84, 1
    s_cmp_ge_u32 s84, 0x100000
    s_cbranch_scc1 L_sbsm_d
    s_cmp_lt_u32 s58, s85
    s_cbranch_scc1 L_sbsm
L_sbsm_d:
    s_branch L_smj
L_qretry:
    s_add_u32 s59, s59, 1
    s_cmp_ge_u32 s59, 60000
    s_cbranch_scc1 L_go
    s_waitcnt lgkmcnt(0)
    s_add_u32 s85, s85, 4
    v_mov_b32 v14, 155648
    v_mov_b32 v15, 1
    s_mov_b64 exec, 1
    ds_add_u32 v14, v15
    s_mov_b64 exec, -1
    s_mov_b32 s84, 0
L_sbqa:
    ds_read_b32 v15, v14
    s_waitcnt lgkmcnt(0)
    v_readfirstlane_b32 s58, v15
    s_add_u32 s84, s84, 1
    s_cmp_ge_u32 s84, 0x100000
    s_cbranch_scc1 L_sbqa_d
    s_cmp_lt_u32 s58, s85
    s_cbranch_scc1 L_sbqa
L_sbqa_d:
    s_add_u32 m0, s64, 0
    s_add_u32 s58, s62, 0
    buffer_load_dwordx4 v16, s[44:47], s58 offen sc1 lds
    s_add_u32 m0, s64, 1024
    s_add_u32 s58, s62, 1024
    buffer_load_dwordx4 v17, s[44:47], s58 offen sc1 lds
    s_add_u32 m0, s64, 2048
    s_add_u32 s58, s62, 2048
    buffer_load_dwordx4 v18, s[44:47], s58 offen sc1 lds
    s_add_u32 m0, s64, 3072
    s_add_u32 s58, s62, 3072
    buffer_load_dwordx4 v19, s[44:47], s58 offen sc1 lds
    buffer_load_dword v24, v20, s[44:47], s63 offen sc1
    v_xor_b32 v10, 0, v21
    ds_read_b128 v[128:131], v10
    v_xor_b32 v10, 16, v21
    ds_read_b128 v[132:135], v10
    v_xor_b32 v10, 32, v21
    ds_read_b128 v[136:139], v10
    v_xor_b32 v10, 48, v21
    ds_read_b128 v[140:143], v10
    v_xor_b32 v10, 64, v21
    ds_read_b128 v[144:147], v10
    v_xor_b32 v10, 80, v21
    ds_read_b128 v[148:151], v10
    v_xor_b32 v10, 96, v21
    ds_read_b128 v[152:155], v10
    v_xor_b32 v10, 112, v21
    ds_read_b128 v[156:159], v10
    v_xor_b32 v10, 128, v21
    ds_read_b128 v[160:163], v10
    v_xor_b32 v10, 144, v21
    ds_read_b128 v[164:167], v10
    v_xor_b32 v10, 160, v21
    ds_read_b128 v[168:171], v10
    v_xor_b32 v10, 176, v21
    ds_read_b128 v[172:175], v10
    v_xor_b32 v10, 192, v21
    ds_read_b128 v[176:179], v10
    v_xor_b32 v10, 208, v21
    ds_read_b128 v[180:183], v10
    v_xor_b32 v10, 224, v21
    ds_read_b128 v[184:187], v10
    v_xor_b32 v10, 240, v21
    ds_read_b128 v[188:191], v10
    v_xor_b32 v240, 0, v22
    v_xor_b32 v224, 16384, v21
    v_xor_b32 v241, 16, v22
    v_xor_b32 v225, 16400, v21
    v_xor_b32 v242, 32, v22
    v_xor_b32 v226, 16416, v21
    v_xor_b32 v243, 48, v22
    v_xor_b32 v227, 16432, v21
    v_xor_b32 v244, 64, v22
    v_xor_b32 v228, 16448, v21
    v_xor_b32 v245, 80, v22
    v_xor_b32 v229, 16464, v21
    v_xor_b32 v246, 96, v22
    v_xor_b32 v230, 16480, v21
    v_xor_b32 v247, 112, v22
    v_xor_b32 v231, 16496, v21
    v_xor_b32 v248, 128, v22
    v_xor_b32 v232, 16512, v21
    v_xor_b32 v249, 144, v22
    v_xor_b32 v233, 16528, v21
    v_xor_b32 v250, 160, v22
    v_xor_b32 v234, 16544, v21
    v_xor_b32 v251, 176, v22
    v_xor_b32 v235, 16560, v21
    v_xor_b32 v252, 192, v22
    v_xor_b32 v236, 16576, v21
    v_xor_b32 v253, 208, v22
    v_xor_b32 v237, 16592, v21
    v_xor_b32 v254, 224, v22
    v_xor_b32 v238, 16608, v21
    v_xor_b32 v255, 240, v22
    v_xor_b32 v239, 16624, v21
    s_waitcnt vmcnt(0) lgkmcnt(0)
    s_add_u32 s85, s85, 4
    v_mov_b32 v14, 155648
    v_mov_b32 v15, 1
    s_mov_b64 exec, 1
    ds_add_u32 v14, v15
    s_mov_b64 exec, -1
    s_mov_b32 s84, 0
L_sbqb:
    ds_read_b32 v15, v14
    s_waitcnt lgkmcnt(0)
    v_readfirstlane_b32 s58, v15
    s_add_u32 s84, s84, 1
    s_cmp_ge_u32 s84, 0x100000
    s_cbranch_scc1 L_sbqb_d
    s_cmp_lt_u32 s58, s85
    s_cbranch_scc1 L_sbqb
L_sbqb_d:
    s_branch L_qk
L_T:
    s_waitcnt lgkmcnt(0)
    s_load_dword s4, s[44:45], 0
    s_lshl_b32 s68, s68, 3
    s_add_u32 s68, s68, s52
    s_lshr_b32 s58, s2, 4
    s_lshl_b32 s56, s52, 4
    s_add_u32 s56, s56, s58
    s_mul_i32 s58, s52, 3
    s_max_u32 s59, s52, 6
    s_sub_u32 s58, s58, s59
    s_add_u32 s58, s58, 6
    s_lshr_b32 s59, s68, 3
    s_add_u32 s58, s58, s59
    s_lshl_b32 s59, s58, 1
    s_cmp_ge_u32 s58, 11
    s_cselect_b32 s58, 21, 0
    s_sub_u32 s59, s59, s58
    s_cmp_lt_u32 s68, 22
    s_cselect_b32 s68, s59, s68
    s_lshl_b32 s66, s3, 15
    s_lshl_b32 s67, s56, 17
    s_add_u32 s67, s67, s66
    s_mov_b32 s85, 0
    s_load_dwordx2 s[24:25], s[0:1], 32
    s_load_dwordx2 s[28:29], s[0:1], 40
    s_mov_b32 s26, 4194304
    s_mov_b32 s27, 0x20000
    s_mov_b32 s30, 4194304
    s_mov_b32 s31, 0x20000
    v_and_b32 v10, 1, v1
    v_cmp_eq_u32 vcc, 1, v10
    v_mov_b32 v11, 0xffff
    v_mov_b32 v12, 0xffff0000
    v_cndmask_b32 v11, v11, v12, vcc
    v_bfe_u32 v10, v1, 1, 2
    v_cmp_eq_u32 vcc, 0, v10
    s_nop 1
    v_cndmask_b32 v6, 0, v11, vcc
    v_cmp_eq_u32 vcc, 1, v10
    s_nop 1
    v_cndmask_b32 v7, 0, v11, vcc
    v_cmp_eq_u32 vcc, 2, v10
    s_nop 1
    v_cndmask_b32 v8, 0, v11, vcc
    v_cmp_eq_u32 vcc, 3, v10
    s_nop 1
    v_cndmask_b32 v9, 0, v11, vcc
    v_and_b32 v10, 1, v1
    v_cmp_ne_u32 s[72:73], 0, v10
    v_and_b32 v10, 2, v1
    v_cmp_ne_u32 s[74:75], 0, v10
    v_cmp_gt_u32 s[76:77], 4, v2
    s_waitcnt lgkmcnt(0)
    s_add_u32 s7, s4, 1
    s_lshl_b32 s4, s7, 2
    s_and_b32 s4, s4, 0x3fff0000
    s_and_b32 s58, s7, 0x3fff
    s_or_b32 s4, s4, s58
    v_lshlrev_b32 v10, 4, v2
    v_lshl_add_u32 v10, v3, 11, v10
    s_lshl_b32 s58, s3, 13
    v_add_u32 v52, s58, v10
    v_xor_b32 v53, 64, v52
    v_xor_b32 v54, 128, v52
    v_xor_b32 v55, 192, v52
    v_lshrrev_b32 v10, 2, v2
    v_and_b32 v11, 3, v2
    s_lshl_b32 s58, s3, 2
    v_or_b32 v11, s58, v11
    v_lshlrev_b32 v12, 2, v10
    v_xor_b32 v11, v11, v12
    v_lshlrev_b32 v11, 4, v11
    v_lshl_add_u32 v10, v3, 3, v10
    v_lshl_add_u32 v47, v10, 8, v11
    v_mov_b32 v16, v4
    s_lshl_b32 s5, s3, 13
    s_lshl_b32 s58, s54, 17
    s_add_u32 s5, s5, s58
    s_lshl_b32 s58, s55, 15
    s_add_u32 s5, s5, s58
    s_add_u32 s5, s5, 2097152
    s_add_u32 s80, s5, 1024
    s_add_u32 s81, s5, 2048
    s_add_u32 s82, s5, 3072
    s_add_u32 s83, s5, 4096
    s_add_u32 s84, s5, 5120
    s_add_u32 s85, s5, 6144
    s_add_u32 s86, s5, 7168
    s_lshl_b32 s58, s3, 13
    s_sub_u32 s5, s5, s58
    s_lshl_b32 s58, s54, 2
    s_add_u32 s58, s58, s55
    s_mul_i32 s58, s58, 17
    s_lshl_b32 s59, s3, 5
    s_add_u32 s58, s58, s59
    v_add_u32 v10, s58, v3
    v_lshlrev_b32 v12, 4, v2
    v_add_u32 v11, 0, v10
    v_and_b32 v11, 127, v11
    v_lshl_add_u32 v164, v11, 8, v12
    v_add_u32 v11, 4, v10
    v_and_b32 v11, 127, v11
    v_lshl_add_u32 v165, v11, 8, v12
    v_add_u32 v11, 8, v10
    v_and_b32 v11, 127, v11
    v_lshl_add_u32 v166, v11, 8, v12
    v_add_u32 v11, 12, v10
    v_and_b32 v11, 127, v11
    v_lshl_add_u32 v167, v11, 8, v12
    v_add_u32 v11, 16, v10
    v_and_b32 v11, 127, v11
    v_lshl_add_u32 v168, v11, 8, v12
    v_add_u32 v11, 20, v10
    v_and_b32 v11, 127, v11
    v_lshl_add_u32 v169, v11, 8, v12
    v_add_u32 v11, 24, v10
    v_and_b32 v11, 127, v11
    v_lshl_add_u32 v170, v11, 8, v12
    v_add_u32 v11, 28, v10
    v_and_b32 v11, 127, v11
    v_lshl_add_u32 v171, v11, 8, v12
    s_and_b32 s58, s3, 1
    v_lshrrev_b32 v10, 3, v2
    v_xor_b32 v10, s58, v10
    v_lshlrev_b32 v10, 5, v10
    v_and_b32 v11, 7, v2
    v_add_u32 v10, v10, v11
    v_lshl_add_u32 v10, v3, 3, v10
    v_lshlrev_b32 v17, 4, v10
    s_lshr_b32 s6, s3, 1
    s_lshl_b32 s6, s6, 10
    s_lshl_b32 s58, s54, 13
    s_add_u32 s6, s6, s58
    s_lshl_b32 s58, s55, 11
    s_add_u32 s6, s6, s58
    s_add_u32 s6, s6, 7340032
    s_lshr_b32 s58, s3, 1
    v_bfe_u32 v10, v1, 3, 1
    v_cmp_eq_u32 vcc, s58, v10
    s_nop 1
    v_cndmask_b32 v24, 0, v6, vcc
    v_cndmask_b32 v25, 0, v7, vcc
    v_cndmask_b32 v26, 0, v8, vcc
    v_cndmask_b32 v27, 0, v9, vcc
    v_lshrrev_b32 v11, 1, v3
    v_cmp_eq_u32 s[78:79], s58, v11
    v_and_b32 v10, 1, v3
    v_lshlrev_b32 v10, 3, v10
    v_lshl_add_u32 v10, v2, 4, v10
    s_mul_i32 s58, s3, 272
    s_add_u32 s58, s58, 154112
    v_add_u32 v18, s58, v10
    v_and_b32 v10, 3, v2
    v_mul_u32_u24 v10, 272, v10
    v_lshl_add_u32 v10, v3, 4, v10
    v_add_u32 v19, 154112, v10
    v_lshrrev_b32 v10, 1, v2
    v_lshlrev_b32 v10, 9, v10
    v_and_b32 v11, 1, v2
    v_lshl_add_u32 v10, v11, 4, v10
    v_lshl_add_u32 v44, v3, 5, v10
    s_and_b32 s58, s3, 1
    s_lshr_b32 s59, s3, 1
    s_lshl_b32 s59, s59, 2
    s_or_b32 s58, s58, s59
    s_lshl_b32 s58, s58, 4
    v_lshrrev_b32 v10, 5, v1
    v_lshlrev_b32 v10, 7, v10
    v_xor_b32 v10, v10, v4
    v_xor_b32 v45, s58, v10
    v_and_b32 v10, 1, v2
    v_bfe_u32 v11, v2, 1, 2
    v_lshl_or_b32 v10, v11, 2, v10
    v_lshlrev_b32 v11, 1, v3
    v_xor_b32 v10, v10, v11
    v_lshlrev_b32 v10, 4, v10
    v_and_b32 v11, 3, v2
    v_lshl_add_u32 v10, v11, 10, v10
    v_bfe_u32 v11, v2, 2, 1
    v_lshl_add_u32 v10, v11, 9, v10
    v_add_u32 v40, 131072, v10
    v_xor_b32 v41, 16, v40
    v_xor_b32 v42, 128, v40
    v_xor_b32 v43, 144, v40
    v_bfe_u32 v10, v2, 2, 1
    v_and_b32 v11, 1, v2
    v_lshl_add_u32 v10, v10, 1, v11
    v_lshlrev_b32 v10, 6, v10
    v_lshl_add_u32 v46, v3, 4, v10
    v_and_b32 v10, 10, v2
    v_cmp_eq_u32 s[74:75], 0, v10
    v_mov_b32 v50, s4
    v_mov_b32 v51, 0
    s_lshl_b32 s62, s54, 12
    s_add_u32 s62, s62, 458752
    s_lshl_b32 s63, s55, 10
    s_add_u32 s63, s63, s62
    s_lshl_b32 s58, s3, 7
    s_add_u32 s63, s63, s58
    s_lshl_b32 s58, s3, 10
    s_add_u32 s62, s62, s58
    s_add_u32 s70, s58, 131072
    s_lshl_b32 s64, s55, 5
    s_add_u32 s64, s64, s54
    s_lshl_b32 s64, s64, 10
    s_lshl_b32 s58, s3, 8
    s_add_u32 s64, s64, s58
    s_add_u32 s64, s64, 589824
    s_lshl_b32 s69, s55, 20
    s_add_u32 s69, s69, s66
    s_lshl_b32 s58, s54, 8
    s_add_u32 s69, s69, s58
    s_lshl_b32 s87, s54, 17
    s_add_u32 s87, s87, s66
    s_lshl_b32 s58, s55, 8
    s_add_u32 s87, s87, s58
    v_mov_b32 v56, -1
    v_mov_b32 v57, -1
    v_mov_b32 v58, -1
    v_mov_b32 v59, -1
    s_cmp_gt_u32 s3, 1
    s_cbranch_scc1 L_wmd
    s_cmp_lt_u32 s3, 1
    s_cbranch_scc1 L_wmd
    s_andn2_b32 s58, s63, 1023
    s_andn2_b32 s59, s64, 1023
    s_cmp_eq_u32 s3, 0
    s_cselect_b32 s58, s58, s59
    buffer_store_dwordx4 v[56:59], v4, s[44:47], s58 offen sc1
L_wmd:
    s_add_u32 s65, s63, 1179648
    s_add_u32 s67, s62, 1179648
    v_cmp_eq_u32 vcc, 0, v2
    s_nop 2
    v_cndmask_b32 v56, 0, v50, vcc
    v_and_b32 v10, 2, v1
    v_cmp_ne_u32 s[36:37], 0, v10
    v_and_b32 v10, 4, v1
    v_cmp_ne_u32 s[32:33], 0, v10
    v_cmp_gt_u32 s[34:35], 8, v2
    s_barrier
    s_barrier
    s_barrier
    buffer_load_dwordx4 v[192:195], v5, s[24:27], s69 offen nt
    s_add_u32 s69, s69, 131072
    buffer_load_dwordx4 v[196:199], v5, s[24:27], s69 offen nt
    s_add_u32 s69, s69, 131072
    buffer_load_dwordx4 v[200:203], v5, s[24:27], s69 offen nt
    s_add_u32 s69, s69, 131072
    buffer_load_dwordx4 v[204:207], v5, s[24:27], s69 offen nt
    s_add_u32 s69, s69, 131072
    buffer_load_dwordx4 v[208:211], v5, s[24:27], s69 offen nt
    s_add_u32 s69, s69, 131072
    buffer_load_dwordx4 v[212:215], v5, s[24:27], s69 offen nt
    s_add_u32 s69, s69, 131072
    buffer_load_dwordx4 v[216:219], v5, s[24:27], s69 offen nt
    s_add_u32 s69, s69, 131072
    buffer_load_dwordx4 v[220:223], v5, s[24:27], s69 offen nt
    s_add_u32 s69, s69, 131072
    s_barrier
    s_barrier
    buffer_load_dwordx4 v[60:63], v4, s[44:47], s67 offen sc1
    s_waitcnt vmcnt(1)
    ds_write_b128 v52, v[192:195] offset:0
    ds_write_b128 v53, v[196:199] offset:256
    ds_write_b128 v54, v[200:203] offset:512
    ds_write_b128 v55, v[204:207] offset:768
    ds_write_b128 v52, v[208:211] offset:1024
    ds_write_b128 v53, v[212:215] offset:1280
    ds_write_b128 v54, v[216:219] offset:1536
    ds_write_b128 v55, v[220:223] offset:1792
    s_waitcnt lgkmcnt(0)
    s_barrier
    s_sleep 7
    buffer_load_dwordx4 v[20:23], v17, s[44:47], s6 offen sc1
    buffer_load_dwordx4 v[64:67], v164, s[44:47], s5 offen sc1
    buffer_load_dwordx4 v[68:71], v165, s[44:47], s5 offen sc1
    buffer_load_dwordx4 v[72:75], v166, s[44:47], s5 offen sc1
    buffer_load_dwordx4 v[76:79], v167, s[44:47], s5 offen sc1
    buffer_load_dwordx4 v[80:83], v168, s[44:47], s5 offen sc1
    buffer_load_dwordx4 v[84:87], v169, s[44:47], s5 offen sc1
    buffer_load_dwordx4 v[88:91], v170, s[44:47], s5 offen sc1
    buffer_load_dwordx4 v[92:95], v171, s[44:47], s5 offen sc1
    ds_read_b64_tr_b16 v[192:193], v47 offset:0
    ds_read_b64_tr_b16 v[194:195], v47 offset:1024
    ds_read_b64_tr_b16 v[196:197], v47 offset:8192
    ds_read_b64_tr_b16 v[198:199], v47 offset:9216
    ds_read_b64_tr_b16 v[200:201], v47 offset:16384
    ds_read_b64_tr_b16 v[202:203], v47 offset:17408
    ds_read_b64_tr_b16 v[204:205], v47 offset:24576
    ds_read_b64_tr_b16 v[206:207], v47 offset:25600
    ds_read_b64_tr_b16 v[208:209], v47 offset:8
    ds_read_b64_tr_b16 v[210:211], v47 offset:1032
    ds_read_b64_tr_b16 v[212:213], v47 offset:8200
    ds_read_b64_tr_b16 v[214:215], v47 offset:9224
    ds_read_b64_tr_b16 v[216:217], v47 offset:16392
    ds_read_b64_tr_b16 v[218:219], v47 offset:17416
    ds_read_b64_tr_b16 v[220:221], v47 offset:24584
    ds_read_b64_tr_b16 v[222:223], v47 offset:25608
    s_mov_b32 s59, 0
    s_branch L_h3a
L_h3:
    buffer_load_dwordx4 v[20:23], v17, s[44:47], s6 offen sc1
    buffer_load_dwordx4 v[64:67], v164, s[44:47], s5 offen sc1
    buffer_load_dwordx4 v[68:71], v165, s[44:47], s5 offen sc1
    buffer_load_dwordx4 v[72:75], v166, s[44:47], s5 offen sc1
    buffer_load_dwordx4 v[76:79], v167, s[44:47], s5 offen sc1
    buffer_load_dwordx4 v[80:83], v168, s[44:47], s5 offen sc1
    buffer_load_dwordx4 v[84:87], v169, s[44:47], s5 offen sc1
    buffer_load_dwordx4 v[88:91], v170, s[44:47], s5 offen sc1
    buffer_load_dwordx4 v[92:95], v171, s[44:47], s5 offen sc1
L_h3a:
    s_waitcnt vmcnt(8)
    v_mov_b32 v29, v20
    s_nop 1
    v_max_f32_dpp v29, v29, v29 row_ror:8 row_mask:0xf bank_mask:0xf
    s_nop 1
    v_max_f32_dpp v29, v29, v29 row_ror:4 row_mask:0xf bank_mask:0xf
    s_nop 1
    v_max_f32_dpp v29, v29, v29 row_ror:2 row_mask:0xf bank_mask:0xf
    s_nop 1
    v_max_f32_dpp v29, v29, v29 row_ror:1 row_mask:0xf bank_mask:0xf
    v_mov_b32 v30, v29
    s_nop 1
    v_permlane16_swap_b32 v30, v29
    v_max_f32 v29, v30, v29
    v_mov_b32 v30, v29
    s_nop 1
    v_permlane32_swap_b32 v30, v29
    v_max_f32 v29, v30, v29
    v_sub_f32 v29, v20, v29
    v_exp_f32 v29, v29
    s_nop 0
    v_mul_f32 v31, v29, v21
    v_cvt_pk_bf16_f32 v29, v29, v29
    s_nop 0
    v_add_f32_dpp v31, v31, v31 row_ror:8 row_mask:0xf bank_mask:0xf
    v_and_b32_dpp v128, v29, v24 row_newbcast:0 row_mask:0xf bank_mask:0xf
    v_and_b32_dpp v129, v29, v25 row_newbcast:0 row_mask:0xf bank_mask:0xf
    v_add_f32_dpp v31, v31, v31 row_ror:4 row_mask:0xf bank_mask:0xf
    v_and_b32_dpp v130, v29, v26 row_newbcast:0 row_mask:0xf bank_mask:0xf
    v_and_b32_dpp v131, v29, v27 row_newbcast:0 row_mask:0xf bank_mask:0xf
    v_add_f32_dpp v31, v31, v31 row_ror:2 row_mask:0xf bank_mask:0xf
    v_and_b32_dpp v132, v29, v24 row_newbcast:1 row_mask:0xf bank_mask:0xf
    v_and_b32_dpp v133, v29, v25 row_newbcast:1 row_mask:0xf bank_mask:0xf
    v_add_f32_dpp v31, v31, v31 row_ror:1 row_mask:0xf bank_mask:0xf
    v_and_b32_dpp v134, v29, v26 row_newbcast:1 row_mask:0xf bank_mask:0xf
    v_and_b32_dpp v135, v29, v27 row_newbcast:1 row_mask:0xf bank_mask:0xf
    v_mov_b32 v30, v31
    v_and_b32_dpp v136, v29, v24 row_newbcast:2 row_mask:0xf bank_mask:0xf
    v_and_b32_dpp v137, v29, v25 row_newbcast:2 row_mask:0xf bank_mask:0xf
    v_permlane16_swap_b32 v30, v31
    v_and_b32_dpp v138, v29, v26 row_newbcast:2 row_mask:0xf bank_mask:0xf
    v_and_b32_dpp v139, v29, v27 row_newbcast:2 row_mask:0xf bank_mask:0xf
    v_add_f32 v31, v30, v31
    v_and_b32_dpp v140, v29, v24 row_newbcast:3 row_mask:0xf bank_mask:0xf
    v_and_b32_dpp v141, v29, v25 row_newbcast:3 row_mask:0xf bank_mask:0xf
    v_mov_b32 v30, v31
    v_and_b32_dpp v142, v29, v26 row_newbcast:3 row_mask:0xf bank_mask:0xf
    v_and_b32_dpp v143, v29, v27 row_newbcast:3 row_mask:0xf bank_mask:0xf
    v_permlane32_swap_b32 v30, v31
    v_and_b32_dpp v144, v29, v24 row_newbcast:4 row_mask:0xf bank_mask:0xf
    v_and_b32_dpp v145, v29, v25 row_newbcast:4 row_mask:0xf bank_mask:0xf
    v_add_f32 v31, v30, v31
    v_and_b32_dpp v146, v29, v26 row_newbcast:4 row_mask:0xf bank_mask:0xf
    v_and_b32_dpp v147, v29, v27 row_newbcast:4 row_mask:0xf bank_mask:0xf
    v_rcp_f32 v31, v31
    v_and_b32_dpp v148, v29, v24 row_newbcast:5 row_mask:0xf bank_mask:0xf
    v_and_b32_dpp v149, v29, v25 row_newbcast:5 row_mask:0xf bank_mask:0xf
    v_and_b32_dpp v150, v29, v26 row_newbcast:5 row_mask:0xf bank_mask:0xf
    v_and_b32_dpp v151, v29, v27 row_newbcast:5 row_mask:0xf bank_mask:0xf
    v_and_b32_dpp v152, v29, v24 row_newbcast:6 row_mask:0xf bank_mask:0xf
    v_and_b32_dpp v153, v29, v25 row_newbcast:6 row_mask:0xf bank_mask:0xf
    v_and_b32_dpp v154, v29, v26 row_newbcast:6 row_mask:0xf bank_mask:0xf
    v_and_b32_dpp v155, v29, v27 row_newbcast:6 row_mask:0xf bank_mask:0xf
    v_and_b32_dpp v156, v29, v24 row_newbcast:7 row_mask:0xf bank_mask:0xf
    v_and_b32_dpp v157, v29, v25 row_newbcast:7 row_mask:0xf bank_mask:0xf
    v_and_b32_dpp v158, v29, v26 row_newbcast:7 row_mask:0xf bank_mask:0xf
    v_and_b32_dpp v159, v29, v27 row_newbcast:7 row_mask:0xf bank_mask:0xf
    s_waitcnt vmcnt(7)
    v_mfma_f32_16x16x32_bf16 v[12:15], v[128:131], v[64:67], 0
    v_add3_u32 v32, v64, v65, v66
    v_add_u32 v32, v32, v67
    s_waitcnt vmcnt(6)
    v_mfma_f32_16x16x32_bf16 v[12:15], v[132:135], v[68:71], v[12:15]
    v_add3_u32 v33, v68, v69, v70
    v_add_u32 v33, v33, v71
    s_waitcnt vmcnt(5)
    v_mfma_f32_16x16x32_bf16 v[12:15], v[136:139], v[72:75], v[12:15]
    v_add3_u32 v34, v72, v73, v74
    v_add_u32 v34, v34, v75
    s_waitcnt vmcnt(4)
    v_mfma_f32_16x16x32_bf16 v[12:15], v[140:143], v[76:79], v[12:15]
    v_add3_u32 v35, v76, v77, v78
    v_add_u32 v35, v35, v79
    s_waitcnt vmcnt(3)
    v_mfma_f32_16x16x32_bf16 v[12:15], v[144:147], v[80:83], v[12:15]
    v_add3_u32 v36, v80, v81, v82
    v_add_u32 v36, v36, v83
    s_waitcnt vmcnt(2)
    v_mfma_f32_16x16x32_bf16 v[12:15], v[148:151], v[84:87], v[12:15]
    v_add3_u32 v37, v84, v85, v86
    v_add_u32 v37, v37, v87
    s_waitcnt vmcnt(1)
    v_mfma_f32_16x16x32_bf16 v[12:15], v[152:155], v[88:91], v[12:15]
    v_add3_u32 v38, v88, v89, v90
    v_add_u32 v38, v38, v91
    s_waitcnt vmcnt(0)
    v_mfma_f32_16x16x32_bf16 v[12:15], v[156:159], v[92:95], v[12:15]
    v_add3_u32 v39, v92, v93, v94
    v_add_u32 v39, v39, v95
    v_cndmask_b32 v160, v33, v32, s[72:73]
    v_cndmask_b32 v32, v32, v33, s[72:73]
    v_cndmask_b32 v161, v35, v34, s[72:73]
    v_cndmask_b32 v34, v34, v35, s[72:73]
    v_cndmask_b32 v162, v37, v36, s[72:73]
    v_cndmask_b32 v36, v36, v37, s[72:73]
    v_cndmask_b32 v163, v39, v38, s[72:73]
    v_cndmask_b32 v38, v38, v39, s[72:73]
    v_add_u32_dpp v32, v160, v32 quad_perm:[1,0,3,2] row_mask:0xf bank_mask:0xf
    v_add_u32_dpp v34, v161, v34 quad_perm:[1,0,3,2] row_mask:0xf bank_mask:0xf
    v_add_u32_dpp v36, v162, v36 quad_perm:[1,0,3,2] row_mask:0xf bank_mask:0xf
    v_add_u32_dpp v38, v163, v38 quad_perm:[1,0,3,2] row_mask:0xf bank_mask:0xf
    v_cndmask_b32 v160, v34, v32, s[36:37]
    v_cndmask_b32 v32, v32, v34, s[36:37]
    v_cndmask_b32 v161, v38, v36, s[36:37]
    v_cndmask_b32 v36, v36, v38, s[36:37]
    v_add_u32_dpp v32, v160, v32 quad_perm:[2,3,0,1] row_mask:0xf bank_mask:0xf
    v_add_u32_dpp v36, v161, v36 quad_perm:[2,3,0,1] row_mask:0xf bank_mask:0xf
    v_cndmask_b32 v160, v36, v32, s[32:33]
    v_cndmask_b32 v32, v32, v36, s[32:33]
    v_xor_b32 v28, s4, v23
    v_subrev_u32 v161, s4, v22
    v_add_u32_dpp v32, v160, v32 row_ror:4 row_mask:0xf bank_mask:0xf
    s_nop 1
    v_add_u32_dpp v32, v32, v32 row_ror:8 row_mask:0xf bank_mask:0xf
    v_xor_b32 v32, v32, v161
    v_cndmask_b32 v32, 0, v32, s[34:35]
    v_or_b32 v57, v28, v32
    v_cmp_ne_u32 vcc, 0, v57
    s_cmp_eq_u64 vcc, 0
    s_cbranch_scc1 L_h3_ok
    s_add_u32 s59, s59, 1
    s_cmp_lt_u32 s59, 60000
    s_cbranch_scc1 L_h3
L_h3_ok:
    v_mul_f32 v12, v12, v31
    v_mul_f32 v13, v13, v31
    v_mul_f32 v14, v14, v31
    v_mul_f32 v15, v15, v31
    v_cvt_pk_bf16_f32 v12, v12, v13
    v_cvt_pk_bf16_f32 v13, v14, v15
    s_mov_b64 exec, s[78:79]
    ds_write_b64 v18, v[12:13]
    s_mov_b64 exec, -1
    buffer_load_dwordx4 v[224:227], v5, s[28:31], s87 offen offset:0 nt
    buffer_load_dwordx4 v[228:231], v5, s[28:31], s87 offen offset:1024 nt
    buffer_load_dwordx4 v[232:235], v5, s[28:31], s87 offen offset:2048 nt
    buffer_load_dwordx4 v[236:239], v5, s[28:31], s87 offen offset:3072 nt
    s_add_u32 s87, s87, 4096
    s_waitcnt lgkmcnt(0)
    s_barrier
    ds_read_b128 v[64:67], v19 offset:0
    ds_read_b128 v[68:71], v19 offset:64
    ds_read_b128 v[72:75], v19 offset:128
    ds_read_b128 v[76:79], v19 offset:192
    buffer_load_dwordx4 v[240:243], v5, s[28:31], s87 offen offset:0 nt
    buffer_load_dwordx4 v[244:247], v5, s[28:31], s87 offen offset:1024 nt
    buffer_load_dwordx4 v[248:251], v5, s[28:31], s87 offen offset:2048 nt
    buffer_load_dwordx4 v[252:255], v5, s[28:31], s87 offen offset:3072 nt
    s_waitcnt lgkmcnt(3)
    v_mfma_f32_16x16x32_bf16 v[32:35], v[192:195], v[64:67], 0
    v_mfma_f32_16x16x32_bf16 v[36:39], v[208:211], v[64:67], 0
    s_waitcnt lgkmcnt(2)
    v_mfma_f32_16x16x32_bf16 v[32:35], v[196:199], v[68:71], v[32:35]
    v_mfma_f32_16x16x32_bf16 v[36:39], v[212:215], v[68:71], v[36:39]
    s_waitcnt lgkmcnt(1)
    v_mfma_f32_16x16x32_bf16 v[32:35], v[200:203], v[72:75], v[32:35]
    v_mfma_f32_16x16x32_bf16 v[36:39], v[216:219], v[72:75], v[36:39]
    s_waitcnt lgkmcnt(0)
    v_mfma_f32_16x16x32_bf16 v[32:35], v[204:207], v[76:79], v[32:35]
    v_mfma_f32_16x16x32_bf16 v[36:39], v[220:223], v[76:79], v[36:39]
    s_nop 6
    v_add_f32_dpp v32, v32, v32 quad_perm:[1,0,3,2] row_mask:0xf bank_mask:0xf
    v_add_f32_dpp v33, v33, v33 quad_perm:[1,0,3,2] row_mask:0xf bank_mask:0xf
    v_add_f32_dpp v34, v34, v34 quad_perm:[1,0,3,2] row_mask:0xf bank_mask:0xf
    v_add_f32_dpp v35, v35, v35 quad_perm:[1,0,3,2] row_mask:0xf bank_mask:0xf
    v_add_f32_dpp v36, v36, v36 quad_perm:[1,0,3,2] row_mask:0xf bank_mask:0xf
    v_add_f32_dpp v37, v37, v37 quad_perm:[1,0,3,2] row_mask:0xf bank_mask:0xf
    v_add_f32_dpp v38, v38, v38 quad_perm:[1,0,3,2] row_mask:0xf bank_mask:0xf
    v_add_f32_dpp v39, v39, v39 quad_perm:[1,0,3,2] row_mask:0xf bank_mask:0xf
    v_cvt_pk_bf16_f32 v32, v32, v33
    v_cvt_pk_bf16_f32 v33, v34, v35
    v_cvt_pk_bf16_f32 v34, v36, v37
    v_cvt_pk_bf16_f32 v35, v38, v39
    v_cndmask_b32 v12, v51, v34, s[72:73]
    v_cndmask_b32 v13, v50, v35, s[72:73]
    v_cndmask_b32 v14, v32, v50, s[72:73]
    v_cndmask_b32 v15, v33, v51, s[72:73]
    s_mov_b64 exec, s[76:77]
    buffer_store_dwordx4 v[12:15], v44, s[44:47], s65 offen
    s_mov_b64 exec, -1
    v_mov_b32 v56, v12
    v_mov_b32 v57, v13
    v_mov_b32 v58, v14
    v_mov_b32 v59, v15
    s_waitcnt vmcnt(1)
    ds_write_b128 v52, v[224:227] offset:32768
    ds_write_b128 v53, v[228:231] offset:33024
    ds_write_b128 v54, v[232:235] offset:33280
    ds_write_b128 v55, v[236:239] offset:33536
    ds_write_b128 v52, v[240:243] offset:33792
    ds_write_b128 v53, v[244:247] offset:34048
    ds_write_b128 v54, v[248:251] offset:34304
    ds_write_b128 v55, v[252:255] offset:34560
    s_waitcnt lgkmcnt(0)
    s_barrier
    s_mov_b32 s59, 0
    s_mov_b32 m0, s70
    s_nop 0
    buffer_load_dwordx4 v45, s[44:47], s67 offen sc1 lds
    ds_read_b64_tr_b16 v[224:225], v47 offset:32768
    ds_read_b64_tr_b16 v[226:227], v47 offset:33792
    ds_read_b64_tr_b16 v[228:229], v47 offset:40960
    ds_read_b64_tr_b16 v[230:231], v47 offset:41984
    ds_read_b64_tr_b16 v[232:233], v47 offset:49152
    ds_read_b64_tr_b16 v[234:235], v47 offset:50176
    ds_read_b64_tr_b16 v[236:237], v47 offset:57344
    ds_read_b64_tr_b16 v[238:239], v47 offset:58368
    ds_read_b64_tr_b16 v[240:241], v47 offset:32776
    ds_read_b64_tr_b16 v[242:243], v47 offset:33800
    ds_read_b64_tr_b16 v[244:245], v47 offset:40968
    ds_read_b64_tr_b16 v[246:247], v47 offset:41992
    ds_read_b64_tr_b16 v[248:249], v47 offset:49160
    ds_read_b64_tr_b16 v[250:251], v47 offset:50184
    ds_read_b64_tr_b16 v[252:253], v47 offset:57352
    ds_read_b64_tr_b16 v[254:255], v47 offset:58376
    s_waitcnt vmcnt(0)
    s_branch L_h4_f
L_h4:
    s_mov_b32 m0, s70
    s_nop 0
    buffer_load_dwordx4 v45, s[44:47], s67 offen sc1 lds
    s_waitcnt vmcnt(0)
L_h4_f:
    s_barrier
    ds_read_b128 v[128:131], v40 offset:0
    ds_read_b128 v[132:135], v41 offset:0
    ds_read_b128 v[136:139], v42 offset:0
    ds_read_b128 v[140:143], v43 offset:0
    ds_read_b128 v[144:147], v40 offset:256
    ds_read_b128 v[148:151], v41 offset:256
    ds_read_b128 v[152:155], v42 offset:256
    ds_read_b128 v[156:159], v43 offset:256
    s_waitcnt lgkmcnt(6)
    v_mfma_f32_16x16x32_bf16 v[32:35], v[224:227], v[130:133], 0
    v_mfma_f32_16x16x32_bf16 v[36:39], v[240:243], v[130:133], 0
    v_xor_b32 v10, s4, v129
    v_xor_b32 v11, s4, v134
    s_waitcnt lgkmcnt(4)
    v_mfma_f32_16x16x32_bf16 v[32:35], v[228:231], v[138:141], v[32:35]
    v_mfma_f32_16x16x32_bf16 v[36:39], v[244:247], v[138:141], v[36:39]
    v_xor_b32 v12, s4, v137
    v_xor_b32 v13, s4, v142
    v_or3_b32 v10, v10, v12, v13
    s_waitcnt lgkmcnt(2)
    v_mfma_f32_16x16x32_bf16 v[32:35], v[232:235], v[146:149], v[32:35]
    v_mfma_f32_16x16x32_bf16 v[36:39], v[248:251], v[146:149], v[36:39]
    v_xor_b32 v12, s4, v145
    v_xor_b32 v13, s4, v150
    v_or3_b32 v10, v10, v12, v13
    s_waitcnt lgkmcnt(0)
    v_mfma_f32_16x16x32_bf16 v[32:35], v[236:239], v[154:157], v[32:35]
    v_mfma_f32_16x16x32_bf16 v[36:39], v[252:255], v[154:157], v[36:39]
    v_xor_b32 v12, s4, v153
    v_xor_b32 v13, s4, v158
    v_or3_b32 v10, v10, v12, v13
    v_or_b32 v10, v10, v11
    v_cmp_ne_u32 vcc, 0, v10
    s_cmp_eq_u64 vcc, 0
    s_cbranch_scc1 L_h4_ok
    s_add_u32 s59, s59, 1
    s_cmp_ge_u32 s59, 60000
    s_cbranch_scc1 L_h4_ok
    s_cmp_lg_u32 s59, 6
    s_cbranch_scc1 L_h4_z
    s_mov_b64 exec, s[76:77]
    buffer_store_dwordx4 v[56:59], v44, s[44:47], s65 offen sc1
    s_mov_b64 exec, -1
L_h4_z:
    s_barrier
    s_branch L_h4
L_h4_ok:
    s_mov_b32 s66, s59
    s_nop 2
    v_cndmask_b32 v64, v36, v32, s[72:73]
    v_cndmask_b32 v32, v32, v36, s[72:73]
    v_cndmask_b32 v65, v37, v33, s[72:73]
    v_cndmask_b32 v33, v33, v37, s[72:73]
    v_cndmask_b32 v66, v38, v34, s[72:73]
    v_cndmask_b32 v34, v34, v38, s[72:73]
    v_cndmask_b32 v67, v39, v35, s[72:73]
    v_cndmask_b32 v35, v35, v39, s[72:73]
    v_add_f32_dpp v32, v64, v32 quad_perm:[1,0,3,2] row_mask:0xf bank_mask:0xf
    v_add_f32_dpp v33, v65, v33 quad_perm:[1,0,3,2] row_mask:0xf bank_mask:0xf
    v_add_f32_dpp v34, v66, v34 quad_perm:[1,0,3,2] row_mask:0xf bank_mask:0xf
    v_add_f32_dpp v35, v67, v35 quad_perm:[1,0,3,2] row_mask:0xf bank_mask:0xf
    v_add_f32_dpp v32, v32, v32 quad_perm:[2,3,0,1] row_mask:0xf bank_mask:0xf
    v_add_f32_dpp v33, v33, v33 quad_perm:[2,3,0,1] row_mask:0xf bank_mask:0xf
    v_add_f32_dpp v34, v34, v34 quad_perm:[2,3,0,1] row_mask:0xf bank_mask:0xf
    v_add_f32_dpp v35, v35, v35 quad_perm:[2,3,0,1] row_mask:0xf bank_mask:0xf
    v_cvt_pk_bf16_f32 v48, v32, v33
    v_cvt_pk_bf16_f32 v49, v34, v35
    s_mov_b64 exec, s[74:75]
    buffer_store_dwordx4 v[48:51], v46, s[44:47], s64 offen sc1
    s_mov_b64 exec, -1
    s_sleep 9
    s_mov_b64 exec, s[76:77]
    buffer_store_dwordx4 v[56:59], v44, s[44:47], s65 offen sc1
    s_mov_b64 exec, -1
L_fin:
L_end:
s_endpgm
.section .rodata,"a"
.p2align 6
.amdhsa_kernel recurrent_scan__compressed_kv_cla__glu_gated_swiglu__decode_kernel
  .amdhsa_next_free_vgpr 256
  .amdhsa_next_free_sgpr 102
  .amdhsa_accum_offset 256
  .amdhsa_group_segment_fixed_size 0
  .amdhsa_kernarg_size 104
  .amdhsa_user_sgpr_count 2
  .amdhsa_user_sgpr_kernarg_segment_ptr 1
  .amdhsa_system_sgpr_workgroup_id_x 1
  .amdhsa_float_denorm_mode_32 3
.end_amdhsa_kernel
```
